```python
import torch

def _softmax(x, axis=-1):
    return torch.softmax(x, dim=axis)
def _gelu(x):
    return torch.nn.functional.gelu(x, approximate="tanh")
def _silu(x):
    return torch.nn.functional.silu(x)
def _sigmoid(x):
    return torch.sigmoid(x)
def _layernorm(x, axis=-1, eps=1e-5):
    m = x.mean(dim=axis, keepdim=True)
    v = x.var(dim=axis, keepdim=True, unbiased=False)
    return (x - m) / torch.sqrt(v + eps)
def _scatter_add(tgt, idx, src, axis=0):
    return tgt.clone().index_add_(axis, idx, src)
def _segment_sum(src, seg, n):
    out = torch.zeros((n,) + src.shape[1:], dtype=src.dtype)
    return out.index_add_(0, seg, src)
def _pad(x, pw):
    flat = tuple(v for pair in reversed(pw) for v in pair)
    return torch.nn.functional.pad(x, flat)

kernel_name = 'sequential_preLN__linear_kernel_hedgehog__mixer_channel_mlp__prompt'

def setup_inputs():

    _w = (lambda a: (lambda t: t.to(torch.bfloat16) if t.is_floating_point() else t)(torch.as_tensor(a)))
    def _A_setup():
        B, S, D, H = 1, 2048, 448, 16
        Dh = D // H
        return {
            "x": _w((lambda *s: torch.randn(*s, dtype=torch.bfloat16) * 0.05)(B, S, D)),
            "wqkv": _w((lambda *s: torch.randn(*s, dtype=torch.bfloat16) * 0.2)(D, 3 * D)),
            "w_phi": _w((lambda *s: torch.randn(*s, dtype=torch.bfloat16) * 0.2)(H, Dh, Dh) * (Dh ** -0.5)),
            "wo": _w((lambda *s: torch.randn(*s, dtype=torch.bfloat16) * 0.05)(D, D)),
        }
    _A_in = _A_setup()

    def _B_setup():
        B, S, D, F = 1, 2048, 448, 1792
        return {
            "x": _w((lambda *s: torch.randn(*s, dtype=torch.bfloat16) * 0.05)(B, S, D)),
            "w1": _w((lambda *s: torch.randn(*s, dtype=torch.bfloat16) * 3.2)(D, F) * (D ** -0.5)),
            "b1": _w((lambda *s: torch.randn(*s, dtype=torch.bfloat16) * 0.8)(F)),
            "w2": _w((lambda *s: torch.randn(*s, dtype=torch.bfloat16) * 0.1)(F, D) * (F ** -0.5)),
            "b2": _w((lambda *s: torch.randn(*s, dtype=torch.bfloat16) * 0.1)(D)),
        }
    _B_in = _B_setup()

    return {
        "A_x": _A_in["x"],
        "A_wqkv": _A_in["wqkv"],
        "A_w_phi": _A_in["w_phi"],
        "A_wo": _A_in["wo"],
        "B_x": _B_in["x"],
        "B_w1": _B_in["w1"],
        "B_b1": _B_in["b1"],
        "B_w2": _B_in["w2"],
        "B_b2": _B_in["b2"],
    }

def reference(A_x, A_wqkv, A_w_phi, A_wo, B_x, B_w1, B_b1, B_w2, B_b2):
    def _A_ref(x, wqkv, w_phi, wo):
        B, S, D = x.shape
        H = 16; Dh = D // H
        qkv = (lambda x, *d: x.permute(*d))((x @ wqkv).reshape(B, S, 3, H, Dh), 2, 0, 3, 1, 4)
        q, k, v = qkv[0], qkv[1], qkv[2]
        pq = torch.einsum("bhsd,hdf->bhsf", q, w_phi)
        pk = torch.einsum("bhsd,hdf->bhsf", k, w_phi)
        phi_q = torch.concatenate([_softmax(pq, axis=-1), _softmax(-pq, axis=-1)], axis=-1)
        phi_k = torch.concatenate([_softmax(pk, axis=-1), _softmax(-pk, axis=-1)], axis=-1)
        kv = torch.einsum("bhsf,bhsd->bhfd", phi_k, v)
        z  = torch.einsum("bhsf->bhf", phi_k)
        num = torch.einsum("bhqf,bhfd->bhqd", phi_q, kv)
        den = torch.einsum("bhqf,bhf->bhq", phi_q, z)[..., None] + 1e-6
        o = num / den
        return (lambda x, *d: x.permute(*d))(o, 0, 2, 1, 3).reshape(B, S, D) @ wo

    def _B_ref(x, w1, b1, w2, b2):
        y = _layernorm(x, axis=-1)
        h = _gelu(torch.einsum("bsd,df->bsf", y, w1) + b1)
        return torch.einsum("bsf,fd->bsd", h, w2) + b2

    x = A_x
    h = x + _A_ref(_layernorm(x, axis=-1), A_wqkv, A_w_phi, A_wo)
    h2 = h + _B_ref(_layernorm(h, axis=-1), B_w1, B_b1, B_w2, B_b2)
    return h2
```

```asm
; @launch grid=(256,1,1) block=(512,1,1) lds=163840
.amdgcn_target "amdgcn-amd-amdhsa--gfx950"
.text
.globl sequential_preLN__linear_kernel_hedgehog__mixer_channel_mlp__prompt_kernel
.p2align 8
.type sequential_preLN__linear_kernel_hedgehog__mixer_channel_mlp__prompt_kernel,@function
sequential_preLN__linear_kernel_hedgehog__mixer_channel_mlp__prompt_kernel:
    s_getpc_b64 s[60:61]
L_pc:
    s_load_dwordx16 s[8:23], s[0:1], 0
    s_load_dwordx8 s[24:31], s[0:1], 64
    s_cmp_ge_u32 s2, 256
    s_cbranch_scc1 L_end
    s_mov_b32 s62, L_code_end-L_pc
    s_mov_b32 s63, 0x00020000
    v_lshlrev_b32 v13, 7, v0
    s_lshl_b32 s76, s2, 9
    s_and_b32 s76, s76, 0x7000
    v_cmp_gt_u32 vcc, 32, v0
    s_nop 0
    s_and_saveexec_b64 s[78:79], vcc
    s_cbranch_execz L_nopf
    buffer_load_dword v140, v13, s[60:63], s76 offen
L_nopf:
    s_mov_b64 exec, -1
    v_and_b32 v1, 63, v0
    v_lshrrev_b32 v14, 6, v0
    s_bfe_u32 s97, s2, 131075
    s_and_b32 s4, s2, 3
    s_lshl_b32 s76, s97, 2
    s_add_u32 s4, s4, s76
    s_lshr_b32 s69, s2, 5
    s_bfe_u32 s68, s2, 65538
    s_cmp_eq_u32 s68, 0
    s_mov_b32 s96, 0xDB9FECA8
    s_cselect_b32 s96, 0x64275310, s96
    s_lshl_b32 s76, s69, 2
    s_lshr_b32 s96, s96, s76
    s_and_b32 s96, s96, 15
    s_mov_b32 s75, 0
    v_readfirstlane_b32 s87, v14
    s_lshl_b32 s76, s97, 1
    s_add_u32 s76, s76, s69
    s_mul_i32 s77, s76, 37
    s_lshr_b32 s77, s77, 8
    s_mul_i32 s77, s77, 7
    s_sub_u32 s7, s76, s77
    s_mov_b32 s74, s7
    v_lshrrev_b32 v14, 2, v1
    v_mul_u32_u24 v14, 2688, v14
    v_and_b32 v15, 3, v1
    v_lshl_add_u32 v25, v15, 4, v14
    v_add_u32 v24, 128, v25
    v_lshrrev_b32 v14, 3, v1
    v_and_b32 v15, 7, v1
    v_lshrrev_b32 v16, 1, v14
    v_xor_b32 v15, v15, v16
    v_mul_u32_u24 v14, 896, v14
    v_lshl_add_u32 v20, v15, 4, v14
    v_xor_b32 v15, 4, v15
    v_lshl_add_u32 v22, v15, 4, v14
    v_add_u32 v21, 6144, v20
    v_add_u32 v23, 18432, v22
    v_add_u32 v22, 12288, v22
    s_and_b32 s6, s87, 3
    s_mul_i32 s71, s6, 43008
    s_mul_i32 s76, s96, 56
    s_andn2_b32 s76, s76, 15
    s_add_u32 s71, s71, s76
    s_add_u32 s71, s71, 768
    s_lshl_b32 s76, s4, 2
    s_add_u32 s76, s76, s6
    s_mul_i32 s70, s76, 28672
    s_lshl_b32 s72, s6, 12
    s_add_u32 s72, s72, 40960
    s_lshl_b32 s73, s6, 11
    v_lshlrev_b32 v19, 7, v1
    s_waitcnt lgkmcnt(0)
    s_mov_b32 s32, s8
    s_mov_b32 s33, s9
    s_mov_b32 s34, 1835008
    s_mov_b32 s35, 0x00020000
    s_mov_b32 s36, s10
    s_mov_b32 s37, s11
    s_mov_b32 s38, 1204224
    s_mov_b32 s39, 0x00020000
    s_cmp_ge_u32 s87, 4
    s_cbranch_scc1 L_com0
    s_setprio 2
    s_lshl_b32 s76, s7, 7
    s_add_u32 s76, s76, s70
    s_add_u32 m0, s72, 0
    s_add_u32 s7, s7, 1
    s_cmp_ge_u32 s7, 7
    s_cselect_b32 s7, 0, s7
    buffer_load_dwordx4 v20, s[32:35], s76 offen offset:0 lds
    buffer_load_dwordx4 v21, s[32:35], s76 offen offset:1024 lds
    buffer_load_dwordx4 v22, s[32:35], s76 offen offset:2048 lds
    buffer_load_dwordx4 v23, s[32:35], s76 offen offset:3072 lds
    s_mul_i32 s77, s74, 172032
    s_add_u32 m0, s73, 0
    s_add_u32 s77, s77, s71
    s_add_u32 s74, s74, 1
    s_cmp_ge_u32 s74, 7
    s_cselect_b32 s74, 0, s74
    buffer_load_dwordx4 v24, s[36:39], s77 offen lds
    buffer_load_dwordx4 v25, s[36:39], s77 offen offset:1024 lds
    s_mov_b32 s40, s30
    s_mov_b32 s41, s31
    s_mov_b32 s42, 17825792
    s_mov_b32 s43, 0x00020000
    s_cmp_eq_u32 s6, 3
    s_cbranch_scc0 L_t3
    v_mov_b32 v64, 0
    v_mov_b32 v65, 0
    v_mov_b32 v66, 0
    v_mov_b32 v67, 0
    v_lshlrev_b32 v14, 4, v1
    s_lshl_b32 s76, s2, 9
    s_mov_b32 exec_hi, 0
    buffer_store_dwordx4 v[64:67], v14, s[40:43], s76 offen sc1
    s_mov_b64 exec, -1
L_t3:
    s_lshl_b32 s76, s7, 7
    s_add_u32 s76, s76, s70
    s_add_u32 m0, s72, 16384
    s_add_u32 s7, s7, 1
    s_cmp_ge_u32 s7, 7
    s_cselect_b32 s7, 0, s7
    buffer_load_dwordx4 v20, s[32:35], s76 offen offset:0 lds
    buffer_load_dwordx4 v21, s[32:35], s76 offen offset:1024 lds
    buffer_load_dwordx4 v22, s[32:35], s76 offen offset:2048 lds
    buffer_load_dwordx4 v23, s[32:35], s76 offen offset:3072 lds
L_com0:
    s_mov_b32 s40, s30
    s_mov_b32 s41, s31
    s_mov_b32 s42, 17825792
    s_mov_b32 s43, 0x00020000
L_com:
    v_and_b32 v2, 31, v1
    v_lshrrev_b32 v3, 5, v1
    v_lshlrev_b32 v5, 4, v1
    v_mov_b32 v11, 1
    v_sub_u32 v14, 1, v3
    v_cvt_f32_u32 v4, v14
    v_mov_b32 v31, 163584
    s_mov_b32 s84, 0x3fb8aa3b
    s_mul_i32 s76, s68, 7
    s_add_u32 s76, s76, s69
    s_add_u32 s5, s68, 14
    s_cmp_lt_u32 s69, 7
    s_cselect_b32 s5, s76, s5
    v_bfe_u32 v14, v1, 2, 2
    v_and_b32 v15, 3, v1
    v_bfe_u32 v16, v1, 4, 1
    v_lshlrev_b32 v15, 3, v15
    v_lshl_add_u32 v15, v16, 5, v15
    v_lshl_add_u32 v16, v3, 3, v14
    v_lshl_add_u32 v6, v16, 6, v15
    s_and_b32 s76, s96, 1
    s_lshl_b32 s76, s76, 3
    v_add_u32 v6, s76, v6
    v_lshl_add_u32 v16, v3, 2, v14
    v_lshl_add_u32 v30, v16, 6, v15
    v_add_u32 v30, 152576, v30
    v_lshl_add_u32 v17, v16, 7, v15
    v_lshrrev_b32 v18, 1, v14
    v_lshl_add_u32 v7, v18, 6, v17
    v_xor_b32 v18, 1, v18
    v_lshl_add_u32 v8, v18, 6, v17
    v_lshrrev_b32 v14, 3, v1
    v_bfe_u32 v15, v1, 4, 1
    v_lshlrev_b32 v15, 2, v15
    v_and_b32 v16, 7, v1
    v_xor_b32 v15, v15, v16
    v_lshlrev_b32 v15, 4, v15
    v_mul_u32_u24 v16, 896, v14
    v_add_u32 v9, v16, v15
    v_mul_u32_u24 v16, 3584, v14
    v_add_u32 v10, v16, v15
    v_bfe_u32 v14, v2, 1, 2
    v_lshrrev_b32 v15, 4, v2
    v_lshl_or_b32 v14, v15, 2, v14
    v_xor_b32 v14, v14, v3
    v_lshlrev_b32 v15, 7, v2
    v_add_u32 v15, s72, v15
    v_xor_b32 v16, 0, v14
    v_lshl_add_u32 v26, v16, 4, v15
    v_xor_b32 v16, 2, v14
    v_lshl_add_u32 v27, v16, 4, v15
    v_xor_b32 v16, 4, v14
    v_lshl_add_u32 v28, v16, 4, v15
    v_xor_b32 v16, 6, v14
    v_lshl_add_u32 v29, v16, 4, v15
    s_mov_b32 s64, s28
    s_mov_b32 s65, s29
    s_mov_b32 s66, 256
    s_mov_b32 s67, 0x00020000
    s_lshl_b32 s76, s97, 1
    s_add_u32 s76, s76, s69
    s_mul_i32 s77, s76, 37
    s_lshr_b32 s77, s77, 8
    s_mul_i32 s77, s77, 7
    s_sub_u32 s29, s76, s77
    s_mov_b32 s29, 0
    s_cmp_ge_u32 s87, 4
    s_cbranch_scc1 L_H
    s_lshl_b32 s76, s4, 2
    s_add_u32 s26, s76, s6
    s_bfe_u32 s77, s26, 65537
    s_mul_i32 s78, s97, 7
    s_add_u32 s78, s78, 1
    s_lshr_b32 s78, s78, 1
    s_sub_u32 s76, s5, s78
    s_add_u32 s77, s76, 14
    s_min_u32 s76, s76, s77
    s_add_u32 s76, s76, 14
    s_and_b32 s77, s76, 3
    s_lshr_b32 s78, s26, 1
    s_lshl_b32 s78, s78, 2
    s_add_u32 s77, s77, s78
    s_lshl_b32 s77, s77, 2
    s_cmp_ge_u32 s76, 28
    s_addc_u32 s77, s77, 0
    s_cmp_ge_u32 s76, 40
    s_addc_u32 s77, s77, 0
    s_lshl_b32 s77, s77, 7
    s_add_u32 s44, s77, 65536
    s_bfe_u32 s77, s26, 65537
    s_mul_i32 s78, s97, 7
    s_add_u32 s78, s78, 1
    s_lshr_b32 s78, s78, 1
    s_sub_u32 s76, s5, s78
    s_add_u32 s77, s76, 14
    s_min_u32 s76, s76, s77
    s_add_u32 s76, s76, 28
    s_and_b32 s77, s76, 3
    s_lshr_b32 s78, s26, 1
    s_lshl_b32 s78, s78, 2
    s_add_u32 s77, s77, s78
    s_lshl_b32 s77, s77, 2
    s_cmp_ge_u32 s76, 28
    s_addc_u32 s77, s77, 0
    s_cmp_ge_u32 s76, 40
    s_addc_u32 s77, s77, 0
    s_lshl_b32 s77, s77, 7
    s_add_u32 s46, s77, 65536
    s_bfe_u32 s77, s26, 65537
    s_mul_i32 s78, s97, 7
    s_add_u32 s78, s78, 1
    s_lshr_b32 s78, s78, 1
    s_sub_u32 s76, s5, s78
    s_add_u32 s77, s76, 14
    s_min_u32 s76, s76, s77
    s_add_u32 s76, s76, 42
    s_and_b32 s77, s76, 3
    s_lshr_b32 s78, s26, 1
    s_lshl_b32 s78, s78, 2
    s_add_u32 s77, s77, s78
    s_lshl_b32 s77, s77, 2
    s_cmp_ge_u32 s76, 28
    s_addc_u32 s77, s77, 0
    s_cmp_ge_u32 s76, 40
    s_addc_u32 s77, s77, 0
    s_lshl_b32 s77, s77, 7
    s_add_u32 s45, s77, 65536
    s_mul_i32 s27, s26, 28672
    s_add_u32 s27, s27, 4194304
    s_add_u32 s76, s29, 0
    s_add_u32 s80, s29, -7
    s_min_u32 s76, s76, s80
    s_lshl_b32 s76, s76, 12
    s_add_u32 s14, s76, s27
    s_add_u32 s76, s29, 1
    s_add_u32 s80, s29, -6
    s_min_u32 s76, s76, s80
    s_lshl_b32 s76, s76, 12
    s_add_u32 s15, s76, s27
    s_add_u32 s76, s29, 2
    s_add_u32 s80, s29, -5
    s_min_u32 s76, s76, s80
    s_lshl_b32 s76, s76, 12
    s_add_u32 s16, s76, s27
    s_add_u32 s76, s29, 3
    s_add_u32 s80, s29, -4
    s_min_u32 s76, s76, s80
    s_lshl_b32 s76, s76, 12
    s_add_u32 s17, s76, s27
    s_add_u32 s76, s29, 4
    s_add_u32 s80, s29, -3
    s_min_u32 s76, s76, s80
    s_lshl_b32 s76, s76, 12
    s_add_u32 s18, s76, s27
    s_add_u32 s76, s29, 5
    s_add_u32 s80, s29, -2
    s_min_u32 s76, s76, s80
    s_lshl_b32 s76, s76, 12
    s_add_u32 s19, s76, s27
    s_add_u32 s76, s29, 6
    s_add_u32 s80, s29, -1
    s_min_u32 s76, s76, s80
    s_lshl_b32 s76, s76, 12
    s_add_u32 s20, s76, s27
    s_and_b32 s76, s6, 1
    s_lshl_b32 s77, s68, 1
    s_add_u32 s76, s76, s77
    s_lshl_b32 s77, s4, 2
    s_add_u32 s86, s76, s77
    s_lshl_b32 s76, s76, 12
    s_lshl_b32 s77, s97, 2
    s_lshr_b32 s77, 0x1300, s77
    s_and_b32 s77, s77, 15
    s_lshl_b32 s77, s77, 14
    s_add_u32 s76, s76, s77
    s_add_u32 s76, s76, 40960
    s_lshr_b32 s77, s6, 1
    s_lshl_b32 s77, s77, 2
    v_bfe_u32 v14, v2, 1, 2
    v_lshrrev_b32 v15, 4, v2
    v_lshl_or_b32 v14, v15, 2, v14
    v_xor_b32 v14, s77, v14
    v_lshlrev_b32 v15, 7, v2
    v_lshl_add_u32 v15, v3, 3, v15
    v_add_u32 v15, s76, v15
    v_xor_b32 v16, 0, v14
    v_lshl_add_u32 v168, v16, 4, v15
    v_xor_b32 v16, 1, v14
    v_lshl_add_u32 v169, v16, 4, v15
    v_xor_b32 v16, 2, v14
    v_lshl_add_u32 v170, v16, 4, v15
    v_xor_b32 v16, 3, v14
    v_lshl_add_u32 v171, v16, 4, v15
    s_waitcnt vmcnt(0)
    s_barrier
    ds_read_b128 v[64:67], v26 offset:0
    ds_read_b64_tr_b16 v[68:69], v6 offset:0
    ds_read_b64_tr_b16 v[70:71], v6 offset:256
    ds_read_b64_tr_b16 v[72:73], v6 offset:1024
    ds_read_b64_tr_b16 v[74:75], v6 offset:1280
    ds_read_b128 v[76:79], v27 offset:0
    ds_read_b64_tr_b16 v[80:81], v6 offset:2048
    ds_read_b64_tr_b16 v[82:83], v6 offset:2304
    ds_read_b64_tr_b16 v[84:85], v6 offset:3072
    ds_read_b64_tr_b16 v[86:87], v6 offset:3328
    ds_read_b128 v[88:91], v28 offset:0
    ds_read_b64_tr_b16 v[92:93], v6 offset:4096
    ds_read_b64_tr_b16 v[94:95], v6 offset:4352
    ds_read_b64_tr_b16 v[96:97], v6 offset:5120
    ds_read_b64_tr_b16 v[98:99], v6 offset:5376
    ds_read_b128 v[100:103], v29 offset:0
    ds_read_b64_tr_b16 v[104:105], v6 offset:6144
    ds_read_b64_tr_b16 v[106:107], v6 offset:6400
    ds_read_b64_tr_b16 v[108:109], v6 offset:7168
    ds_read_b64_tr_b16 v[110:111], v6 offset:7424
    s_cmp_eq_u32 s6, 3
    s_cbranch_scc0 L_t7
    s_and_b32 s76, s2, 3
    s_lshl_b32 s76, s76, 6
    s_mov_b64 exec, 1
    buffer_atomic_add v11, off, s[64:67], s76
    s_mov_b64 exec, -1
L_t7:
    s_add_u32 s7, s7, 1
    s_cmp_ge_u32 s7, 7
    s_cselect_b32 s76, 7, 0
    s_sub_u32 s7, s7, s76
    s_add_u32 s74, s74, 1
    s_cmp_ge_u32 s74, 7
    s_cselect_b32 s76, 7, 0
    s_sub_u32 s74, s74, s76
    s_mul_i32 s77, s74, 172032
    s_add_u32 m0, s73, 16384
    s_add_u32 s77, s77, s71
    s_add_u32 s74, s74, 1
    s_cmp_ge_u32 s74, 7
    s_cselect_b32 s74, 0, s74
    buffer_load_dwordx4 v24, s[36:39], s77 offen lds
    buffer_load_dwordx4 v25, s[36:39], s77 offen offset:1024 lds
    s_lshl_b32 s76, s7, 7
    s_add_u32 s76, s76, s70
    s_add_u32 m0, s72, 49152
    s_add_u32 s7, s7, 1
    s_cmp_ge_u32 s7, 7
    s_cselect_b32 s7, 0, s7
    buffer_load_dwordx4 v20, s[32:35], s76 offen offset:0 lds
    buffer_load_dwordx4 v21, s[32:35], s76 offen offset:1024 lds
    buffer_load_dwordx4 v22, s[32:35], s76 offen offset:2048 lds
    buffer_load_dwordx4 v23, s[32:35], s76 offen offset:3072 lds
    s_cmp_eq_u32 s97, 0
    s_cbranch_scc0 L_res_1
    ds_read_b64 v[160:161], v168
    ds_read_b64 v[162:163], v169
    ds_read_b64 v[164:165], v170
    ds_read_b64 v[166:167], v171
L_res_1:
    s_waitcnt lgkmcnt(0)
    s_barrier
    v_mfma_f32_32x32x16_bf16 v[32:47], v[68:71], v[64:67], 0
    ds_read_b128 v[112:115], v26 offset:16384
    ds_read_b64_tr_b16 v[116:117], v6 offset:8192
    ds_read_b64_tr_b16 v[118:119], v6 offset:8448
    v_mfma_f32_32x32x16_bf16 v[48:63], v[72:75], v[64:67], 0
    ds_read_b64_tr_b16 v[120:121], v6 offset:9216
    ds_read_b64_tr_b16 v[122:123], v6 offset:9472
    v_mfma_f32_32x32x16_bf16 v[32:47], v[80:83], v[76:79], v[32:47]
    ds_read_b128 v[124:127], v27 offset:16384
    ds_read_b64_tr_b16 v[128:129], v6 offset:10240
    ds_read_b64_tr_b16 v[130:131], v6 offset:10496
    v_mfma_f32_32x32x16_bf16 v[48:63], v[84:87], v[76:79], v[48:63]
    ds_read_b64_tr_b16 v[132:133], v6 offset:11264
    ds_read_b64_tr_b16 v[134:135], v6 offset:11520
    v_mfma_f32_32x32x16_bf16 v[32:47], v[92:95], v[88:91], v[32:47]
    ds_read_b128 v[136:139], v28 offset:16384
    ds_read_b64_tr_b16 v[140:141], v6 offset:12288
    ds_read_b64_tr_b16 v[142:143], v6 offset:12544
    v_mfma_f32_32x32x16_bf16 v[48:63], v[96:99], v[88:91], v[48:63]
    ds_read_b64_tr_b16 v[144:145], v6 offset:13312
    ds_read_b64_tr_b16 v[146:147], v6 offset:13568
    v_mfma_f32_32x32x16_bf16 v[32:47], v[104:107], v[100:103], v[32:47]
    ds_read_b128 v[148:151], v29 offset:16384
    ds_read_b64_tr_b16 v[152:153], v6 offset:14336
    ds_read_b64_tr_b16 v[154:155], v6 offset:14592
    v_mfma_f32_32x32x16_bf16 v[48:63], v[108:111], v[100:103], v[48:63]
    ds_read_b64_tr_b16 v[156:157], v6 offset:15360
    ds_read_b64_tr_b16 v[158:159], v6 offset:15616
    s_mul_i32 s77, s74, 172032
    s_add_u32 m0, s73, 24576
    s_add_u32 s77, s77, s71
    s_add_u32 s74, s74, 1
    s_cmp_ge_u32 s74, 7
    s_cselect_b32 s74, 0, s74
    buffer_load_dwordx4 v24, s[36:39], s77 offen lds
    buffer_load_dwordx4 v25, s[36:39], s77 offen offset:1024 lds
    s_lshl_b32 s76, s7, 7
    s_add_u32 s76, s76, s70
    s_add_u32 m0, s72, 65536
    s_add_u32 s7, s7, 1
    s_cmp_ge_u32 s7, 7
    s_cselect_b32 s7, 0, s7
    buffer_load_dwordx4 v20, s[32:35], s76 offen offset:0 lds
    buffer_load_dwordx4 v21, s[32:35], s76 offen offset:1024 lds
    buffer_load_dwordx4 v22, s[32:35], s76 offen offset:2048 lds
    buffer_load_dwordx4 v23, s[32:35], s76 offen offset:3072 lds
    s_cmp_eq_u32 s97, 3
    s_cbranch_scc0 L_res_2
    ds_read_b64 v[160:161], v168
    ds_read_b64 v[162:163], v169
    ds_read_b64 v[164:165], v170
    ds_read_b64 v[166:167], v171
L_res_2:
    s_waitcnt vmcnt(6) lgkmcnt(0)
    s_barrier
    v_mfma_f32_32x32x16_bf16 v[32:47], v[116:119], v[112:115], v[32:47]
    ds_read_b128 v[64:67], v26 offset:32768
    ds_read_b64_tr_b16 v[68:69], v6 offset:16384
    ds_read_b64_tr_b16 v[70:71], v6 offset:16640
    v_mfma_f32_32x32x16_bf16 v[48:63], v[120:123], v[112:115], v[48:63]
    ds_read_b64_tr_b16 v[72:73], v6 offset:17408
    ds_read_b64_tr_b16 v[74:75], v6 offset:17664
    v_mfma_f32_32x32x16_bf16 v[32:47], v[128:131], v[124:127], v[32:47]
    ds_read_b128 v[76:79], v27 offset:32768
    ds_read_b64_tr_b16 v[80:81], v6 offset:18432
    ds_read_b64_tr_b16 v[82:83], v6 offset:18688
    v_mfma_f32_32x32x16_bf16 v[48:63], v[132:135], v[124:127], v[48:63]
    ds_read_b64_tr_b16 v[84:85], v6 offset:19456
    ds_read_b64_tr_b16 v[86:87], v6 offset:19712
    v_mfma_f32_32x32x16_bf16 v[32:47], v[140:143], v[136:139], v[32:47]
    ds_read_b128 v[88:91], v28 offset:32768
    ds_read_b64_tr_b16 v[92:93], v6 offset:20480
    ds_read_b64_tr_b16 v[94:95], v6 offset:20736
    v_mfma_f32_32x32x16_bf16 v[48:63], v[144:147], v[136:139], v[48:63]
    ds_read_b64_tr_b16 v[96:97], v6 offset:21504
    ds_read_b64_tr_b16 v[98:99], v6 offset:21760
    v_mfma_f32_32x32x16_bf16 v[32:47], v[152:155], v[148:151], v[32:47]
    ds_read_b128 v[100:103], v29 offset:32768
    ds_read_b64_tr_b16 v[104:105], v6 offset:22528
    ds_read_b64_tr_b16 v[106:107], v6 offset:22784
    v_mfma_f32_32x32x16_bf16 v[48:63], v[156:159], v[148:151], v[48:63]
    ds_read_b64_tr_b16 v[108:109], v6 offset:23552
    ds_read_b64_tr_b16 v[110:111], v6 offset:23808
    s_mul_i32 s77, s74, 172032
    s_add_u32 m0, s73, 32768
    s_add_u32 s77, s77, s71
    s_add_u32 s74, s74, 1
    s_cmp_ge_u32 s74, 7
    s_cselect_b32 s74, 0, s74
    buffer_load_dwordx4 v24, s[36:39], s77 offen lds
    buffer_load_dwordx4 v25, s[36:39], s77 offen offset:1024 lds
    s_lshl_b32 s76, s7, 7
    s_add_u32 s76, s76, s70
    s_add_u32 m0, s72, 0
    s_add_u32 s7, s7, 1
    s_cmp_ge_u32 s7, 7
    s_cselect_b32 s7, 0, s7
    buffer_load_dwordx4 v20, s[32:35], s76 offen offset:0 lds
    buffer_load_dwordx4 v21, s[32:35], s76 offen offset:1024 lds
    buffer_load_dwordx4 v22, s[32:35], s76 offen offset:2048 lds
    buffer_load_dwordx4 v23, s[32:35], s76 offen offset:3072 lds
    s_waitcnt vmcnt(6) lgkmcnt(0)
    s_barrier
    v_mfma_f32_32x32x16_bf16 v[32:47], v[68:71], v[64:67], v[32:47]
    ds_read_b128 v[112:115], v26 offset:49152
    ds_read_b64_tr_b16 v[116:117], v6 offset:24576
    ds_read_b64_tr_b16 v[118:119], v6 offset:24832
    v_mfma_f32_32x32x16_bf16 v[48:63], v[72:75], v[64:67], v[48:63]
    ds_read_b64_tr_b16 v[120:121], v6 offset:25600
    ds_read_b64_tr_b16 v[122:123], v6 offset:25856
    v_mfma_f32_32x32x16_bf16 v[32:47], v[80:83], v[76:79], v[32:47]
    ds_read_b128 v[124:127], v27 offset:49152
    ds_read_b64_tr_b16 v[128:129], v6 offset:26624
    ds_read_b64_tr_b16 v[130:131], v6 offset:26880
    v_mfma_f32_32x32x16_bf16 v[48:63], v[84:87], v[76:79], v[48:63]
    ds_read_b64_tr_b16 v[132:133], v6 offset:27648
    ds_read_b64_tr_b16 v[134:135], v6 offset:27904
    v_mfma_f32_32x32x16_bf16 v[32:47], v[92:95], v[88:91], v[32:47]
    ds_read_b128 v[136:139], v28 offset:49152
    ds_read_b64_tr_b16 v[140:141], v6 offset:28672
    ds_read_b64_tr_b16 v[142:143], v6 offset:28928
    v_mfma_f32_32x32x16_bf16 v[48:63], v[96:99], v[88:91], v[48:63]
    ds_read_b64_tr_b16 v[144:145], v6 offset:29696
    ds_read_b64_tr_b16 v[146:147], v6 offset:29952
    v_mfma_f32_32x32x16_bf16 v[32:47], v[104:107], v[100:103], v[32:47]
    ds_read_b128 v[148:151], v29 offset:49152
    ds_read_b64_tr_b16 v[152:153], v6 offset:30720
    ds_read_b64_tr_b16 v[154:155], v6 offset:30976
    v_mfma_f32_32x32x16_bf16 v[48:63], v[108:111], v[100:103], v[48:63]
    ds_read_b64_tr_b16 v[156:157], v6 offset:31744
    ds_read_b64_tr_b16 v[158:159], v6 offset:32000
    s_mul_i32 s77, s74, 172032
    s_add_u32 m0, s73, 0
    s_add_u32 s77, s77, s71
    s_add_u32 s74, s74, 1
    s_cmp_ge_u32 s74, 7
    s_cselect_b32 s74, 0, s74
    buffer_load_dwordx4 v24, s[36:39], s77 offen lds
    buffer_load_dwordx4 v25, s[36:39], s77 offen offset:1024 lds
    s_lshl_b32 s76, s7, 7
    s_add_u32 s76, s76, s70
    s_add_u32 m0, s72, 16384
    s_add_u32 s7, s7, 1
    s_cmp_ge_u32 s7, 7
    s_cselect_b32 s7, 0, s7
    buffer_load_dwordx4 v20, s[32:35], s76 offen offset:0 lds
    buffer_load_dwordx4 v21, s[32:35], s76 offen offset:1024 lds
    buffer_load_dwordx4 v22, s[32:35], s76 offen offset:2048 lds
    buffer_load_dwordx4 v23, s[32:35], s76 offen offset:3072 lds
    s_cmp_eq_u32 s97, 2
    s_cbranch_scc0 L_res_3
    ds_read_b64 v[160:161], v168
    ds_read_b64 v[162:163], v169
    ds_read_b64 v[164:165], v170
    ds_read_b64 v[166:167], v171
L_res_3:
    s_waitcnt vmcnt(6) lgkmcnt(0)
    s_barrier
    v_add_u32 v26, 0x10000, v26
    v_add_u32 v27, 0x10000, v27
    v_add_u32 v28, 0x10000, v28
    v_add_u32 v29, 0x10000, v29
    v_mfma_f32_32x32x16_bf16 v[32:47], v[116:119], v[112:115], v[32:47]
    ds_read_b128 v[64:67], v26 offset:0
    ds_read_b64_tr_b16 v[68:69], v6 offset:32768
    ds_read_b64_tr_b16 v[70:71], v6 offset:33024
    v_mfma_f32_32x32x16_bf16 v[48:63], v[120:123], v[112:115], v[48:63]
    ds_read_b64_tr_b16 v[72:73], v6 offset:33792
    ds_read_b64_tr_b16 v[74:75], v6 offset:34048
    v_mfma_f32_32x32x16_bf16 v[32:47], v[128:131], v[124:127], v[32:47]
    ds_read_b128 v[76:79], v27 offset:0
    ds_read_b64_tr_b16 v[80:81], v6 offset:34816
    ds_read_b64_tr_b16 v[82:83], v6 offset:35072
    v_mfma_f32_32x32x16_bf16 v[48:63], v[132:135], v[124:127], v[48:63]
    ds_read_b64_tr_b16 v[84:85], v6 offset:35840
    ds_read_b64_tr_b16 v[86:87], v6 offset:36096
    v_mfma_f32_32x32x16_bf16 v[32:47], v[140:143], v[136:139], v[32:47]
    ds_read_b128 v[88:91], v28 offset:0
    ds_read_b64_tr_b16 v[92:93], v6 offset:36864
    ds_read_b64_tr_b16 v[94:95], v6 offset:37120
    v_mfma_f32_32x32x16_bf16 v[48:63], v[144:147], v[136:139], v[48:63]
    ds_read_b64_tr_b16 v[96:97], v6 offset:37888
    ds_read_b64_tr_b16 v[98:99], v6 offset:38144
    v_mfma_f32_32x32x16_bf16 v[32:47], v[152:155], v[148:151], v[32:47]
    ds_read_b128 v[100:103], v29 offset:0
    ds_read_b64_tr_b16 v[104:105], v6 offset:38912
    ds_read_b64_tr_b16 v[106:107], v6 offset:39168
    v_mfma_f32_32x32x16_bf16 v[48:63], v[156:159], v[148:151], v[48:63]
    ds_read_b64_tr_b16 v[108:109], v6 offset:39936
    ds_read_b64_tr_b16 v[110:111], v6 offset:40192
    s_mul_i32 s77, s74, 172032
    s_add_u32 m0, s73, 8192
    s_add_u32 s77, s77, s71
    s_add_u32 s74, s74, 1
    s_cmp_ge_u32 s74, 7
    s_cselect_b32 s74, 0, s74
    buffer_load_dwordx4 v24, s[36:39], s77 offen lds
    buffer_load_dwordx4 v25, s[36:39], s77 offen offset:1024 lds
    s_waitcnt vmcnt(2) lgkmcnt(0)
    s_barrier
    v_subrev_u32 v26, 0x10000, v26
    v_subrev_u32 v27, 0x10000, v27
    v_subrev_u32 v28, 0x10000, v28
    v_subrev_u32 v29, 0x10000, v29
    v_mfma_f32_32x32x16_bf16 v[32:47], v[68:71], v[64:67], v[32:47]
    ds_read_b128 v[112:115], v26 offset:0
    ds_read_b64_tr_b16 v[116:117], v6 offset:0
    ds_read_b64_tr_b16 v[118:119], v6 offset:256
    v_mfma_f32_32x32x16_bf16 v[48:63], v[72:75], v[64:67], v[48:63]
    ds_read_b64_tr_b16 v[120:121], v6 offset:1024
    ds_read_b64_tr_b16 v[122:123], v6 offset:1280
    v_mfma_f32_32x32x16_bf16 v[32:47], v[80:83], v[76:79], v[32:47]
    ds_read_b128 v[124:127], v27 offset:0
    ds_read_b64_tr_b16 v[128:129], v6 offset:2048
    ds_read_b64_tr_b16 v[130:131], v6 offset:2304
    v_mfma_f32_32x32x16_bf16 v[48:63], v[84:87], v[76:79], v[48:63]
    ds_read_b64_tr_b16 v[132:133], v6 offset:3072
    ds_read_b64_tr_b16 v[134:135], v6 offset:3328
    v_mfma_f32_32x32x16_bf16 v[32:47], v[92:95], v[88:91], v[32:47]
    ds_read_b128 v[136:139], v28 offset:0
    ds_read_b64_tr_b16 v[140:141], v6 offset:4096
    ds_read_b64_tr_b16 v[142:143], v6 offset:4352
    v_mfma_f32_32x32x16_bf16 v[48:63], v[96:99], v[88:91], v[48:63]
    ds_read_b64_tr_b16 v[144:145], v6 offset:5120
    ds_read_b64_tr_b16 v[146:147], v6 offset:5376
    v_mfma_f32_32x32x16_bf16 v[32:47], v[104:107], v[100:103], v[32:47]
    ds_read_b128 v[148:151], v29 offset:0
    ds_read_b64_tr_b16 v[152:153], v6 offset:6144
    ds_read_b64_tr_b16 v[154:155], v6 offset:6400
    v_mfma_f32_32x32x16_bf16 v[48:63], v[108:111], v[100:103], v[48:63]
    ds_read_b64_tr_b16 v[156:157], v6 offset:7168
    ds_read_b64_tr_b16 v[158:159], v6 offset:7424
    s_lshl_b32 s73, s6, 10
    s_add_u32 s73, s73, 98304
    s_sub_u32 s71, s71, 768
    s_cmp_eq_u32 s97, 1
    s_cbranch_scc0 L_res_4
    ds_read_b64 v[160:161], v168
    ds_read_b64 v[162:163], v169
    ds_read_b64 v[164:165], v170
    ds_read_b64 v[166:167], v171
L_res_4:
    s_waitcnt lgkmcnt(15)
    v_mfma_f32_32x32x16_bf16 v[32:47], v[116:119], v[112:115], v[32:47]
    s_mul_i32 s77, s74, 172032
    s_add_u32 m0, s73, 0
    s_add_u32 s77, s77, s71
    buffer_load_dwordx4 v25, s[36:39], s77 offen lds
    s_add_u32 s74, s74, 1
    s_cmp_ge_u32 s74, 7
    s_cselect_b32 s74, 0, s74
    v_mfma_f32_32x32x16_bf16 v[48:63], v[120:123], v[112:115], v[48:63]
    s_mul_i32 s77, s74, 172032
    s_add_u32 m0, s73, 4096
    s_add_u32 s77, s77, s71
    buffer_load_dwordx4 v25, s[36:39], s77 offen lds
    s_add_u32 s74, s74, 1
    s_cmp_ge_u32 s74, 7
    s_cselect_b32 s74, 0, s74
    s_waitcnt lgkmcnt(10)
    v_mfma_f32_32x32x16_bf16 v[32:47], v[128:131], v[124:127], v[32:47]
    s_mul_i32 s77, s74, 172032
    s_add_u32 m0, s73, 8192
    s_add_u32 s77, s77, s71
    buffer_load_dwordx4 v25, s[36:39], s77 offen lds
    s_add_u32 s74, s74, 1
    s_cmp_ge_u32 s74, 7
    s_cselect_b32 s74, 0, s74
    v_mfma_f32_32x32x16_bf16 v[48:63], v[132:135], v[124:127], v[48:63]
    s_mul_i32 s77, s74, 172032
    s_add_u32 m0, s73, 12288
    s_add_u32 s77, s77, s71
    buffer_load_dwordx4 v25, s[36:39], s77 offen lds
    s_add_u32 s74, s74, 1
    s_cmp_ge_u32 s74, 7
    s_cselect_b32 s74, 0, s74
    s_waitcnt lgkmcnt(5)
    v_mfma_f32_32x32x16_bf16 v[32:47], v[140:143], v[136:139], v[32:47]
    s_mul_i32 s77, s74, 172032
    s_add_u32 m0, s73, 16384
    s_add_u32 s77, s77, s71
    buffer_load_dwordx4 v25, s[36:39], s77 offen lds
    s_add_u32 s74, s74, 1
    s_cmp_ge_u32 s74, 7
    s_cselect_b32 s74, 0, s74
    v_mfma_f32_32x32x16_bf16 v[48:63], v[144:147], v[136:139], v[48:63]
    s_mul_i32 s77, s74, 172032
    s_add_u32 m0, s73, 20480
    s_add_u32 s77, s77, s71
    buffer_load_dwordx4 v25, s[36:39], s77 offen lds
    s_add_u32 s74, s74, 1
    s_cmp_ge_u32 s74, 7
    s_cselect_b32 s74, 0, s74
    s_waitcnt lgkmcnt(0)
    v_mfma_f32_32x32x16_bf16 v[32:47], v[152:155], v[148:151], v[32:47]
    s_mul_i32 s77, s74, 172032
    s_add_u32 m0, s73, 24576
    s_add_u32 s77, s77, s71
    buffer_load_dwordx4 v25, s[36:39], s77 offen lds
    v_mfma_f32_32x32x16_bf16 v[48:63], v[156:159], v[148:151], v[48:63]
    s_waitcnt vmcnt(7)
    s_barrier
    ds_read_b128 v[64:67], v26 offset:16384
    ds_read_b64_tr_b16 v[68:69], v6 offset:8192
    ds_read_b64_tr_b16 v[70:71], v6 offset:8448
    ds_read_b64_tr_b16 v[72:73], v6 offset:9216
    ds_read_b64_tr_b16 v[74:75], v6 offset:9472
    ds_read_b128 v[76:79], v27 offset:16384
    ds_read_b64_tr_b16 v[80:81], v6 offset:10240
    ds_read_b64_tr_b16 v[82:83], v6 offset:10496
    ds_read_b64_tr_b16 v[84:85], v6 offset:11264
    ds_read_b64_tr_b16 v[86:87], v6 offset:11520
    ds_read_b128 v[88:91], v28 offset:16384
    ds_read_b64_tr_b16 v[92:93], v6 offset:12288
    ds_read_b64_tr_b16 v[94:95], v6 offset:12544
    ds_read_b64_tr_b16 v[96:97], v6 offset:13312
    ds_read_b64_tr_b16 v[98:99], v6 offset:13568
    ds_read_b128 v[100:103], v29 offset:16384
    ds_read_b64_tr_b16 v[104:105], v6 offset:14336
    ds_read_b64_tr_b16 v[106:107], v6 offset:14592
    ds_read_b64_tr_b16 v[108:109], v6 offset:15360
    ds_read_b64_tr_b16 v[110:111], v6 offset:15616
    s_waitcnt lgkmcnt(15)
    v_mfma_f32_32x32x16_bf16 v[32:47], v[68:71], v[64:67], v[32:47]
    v_mfma_f32_32x32x16_bf16 v[48:63], v[72:75], v[64:67], v[48:63]
    s_waitcnt lgkmcnt(10)
    v_mfma_f32_32x32x16_bf16 v[32:47], v[80:83], v[76:79], v[32:47]
    v_mfma_f32_32x32x16_bf16 v[48:63], v[84:87], v[76:79], v[48:63]
    s_waitcnt lgkmcnt(5)
    v_mfma_f32_32x32x16_bf16 v[32:47], v[92:95], v[88:91], v[32:47]
    v_mfma_f32_32x32x16_bf16 v[48:63], v[96:99], v[88:91], v[48:63]
    s_waitcnt lgkmcnt(0)
    v_mfma_f32_32x32x16_bf16 v[32:47], v[104:107], v[100:103], v[32:47]
    v_mfma_f32_32x32x16_bf16 v[48:63], v[108:111], v[100:103], v[48:63]
    s_lshl_b32 s76, s6, 10
    s_add_u32 s76, s76, 154624
    v_add_u32 v16, s76, v5
    v_add_u32 v18, 158720, v5
    s_mul_i32 s76, s6, 6400
    s_add_u32 s76, s76, 126976
    v_mul_u32_u24 v17, 200, v2
    v_lshl_add_u32 v17, v3, 3, v17
    v_add_u32 v17, s76, v17
    ds_read_b64_tr_b16 v[184:185], v30 offset:0
    ds_read_b64_tr_b16 v[186:187], v30 offset:512
    ds_read_b64_tr_b16 v[188:189], v30 offset:1024
    ds_read_b64_tr_b16 v[190:191], v30 offset:1536
    v_sub_f32 v22, 1.0, v4
    v_lshlrev_b32 v21, 6, v1
    s_mov_b64 exec, 15
    buffer_load_dword v24, v21, s[64:67], 0 offen sc1
    s_mov_b64 exec, -1
    s_barrier
    ds_read_b128 v[176:179], v16
    ds_read_b128 v[168:171], v18
    ds_read_b128 v[172:175], v18 offset:1024
    s_waitcnt lgkmcnt(0)
    v_mov_b32 v180, v178
    v_add_u32 v181, -1, v3
    v_mov_b32 v178, v176
    v_mov_b32 v179, v177
    s_nop 1
    v_mfma_f32_32x32x16_bf16 v[32:47], v[168:171], v[176:179], v[32:47]
    v_mfma_f32_32x32x16_bf16 v[48:63], v[172:175], v[176:179], v[48:63]
    s_nop 10
    v_cvt_pk_bf16_f32 v64, v32, v33
    v_cvt_pk_bf16_f32 v65, v34, v35
    v_cvt_pk_bf16_f32 v66, v36, v37
    v_cvt_pk_bf16_f32 v67, v38, v39
    v_cvt_pk_bf16_f32 v68, v40, v41
    v_cvt_pk_bf16_f32 v69, v42, v43
    v_cvt_pk_bf16_f32 v70, v44, v45
    v_cvt_pk_bf16_f32 v71, v46, v47
    v_mfma_f32_32x32x16_bf16 v[32:47], v[184:187], v[64:67], 0
    s_nop 0
    v_mfma_f32_32x32x16_bf16 v[32:47], v[188:191], v[68:71], v[32:47]
    v_mul_f32 v48, v48, v180
    v_mul_f32 v49, v49, v180
    v_mul_f32 v50, v50, v180
    v_mul_f32 v51, v51, v180
    v_mul_f32 v52, v52, v180
    v_mul_f32 v53, v53, v180
    v_mul_f32 v54, v54, v180
    v_mul_f32 v55, v55, v180
    v_mul_f32 v56, v56, v180
    v_mul_f32 v57, v57, v180
    v_mul_f32 v58, v58, v180
    v_mul_f32 v59, v59, v180
    v_and_b32 v60, v181, v60
    v_and_b32 v61, v181, v61
    v_and_b32 v62, v181, v62
    v_and_b32 v63, v181, v63
    v_fma_f32 v60, v60, v180, v22
    v_mul_f32 v61, v61, v180
    v_mul_f32 v62, v62, v180
    v_mul_f32 v63, v63, v180
    v_cvt_pk_bf16_f32 v112, v48, v49
    v_cvt_pk_bf16_f32 v113, v50, v51
    v_cvt_pk_bf16_f32 v114, v52, v53
    v_cvt_pk_bf16_f32 v115, v54, v55
    v_cvt_pk_bf16_f32 v116, v56, v57
    v_cvt_pk_bf16_f32 v117, v58, v59
    v_cvt_pk_bf16_f32 v118, v60, v61
    v_cvt_pk_bf16_f32 v119, v62, v63
    ds_write_b64 v17, v[112:113] offset:128
    ds_write_b64 v17, v[114:115] offset:144
    ds_write_b64 v17, v[116:117] offset:160
    ds_write_b64 v17, v[118:119] offset:176
    v_max3_f32 v80, v32, v33, v34
    v_min3_f32 v81, v32, v33, v34
    v_max3_f32 v80, v35, v36, v80
    v_min3_f32 v81, v35, v36, v81
    v_max3_f32 v80, v37, v38, v80
    v_min3_f32 v81, v37, v38, v81
    v_max3_f32 v80, v39, v40, v80
    v_min3_f32 v81, v39, v40, v81
    v_max3_f32 v80, v41, v42, v80
    v_min3_f32 v81, v41, v42, v81
    v_max3_f32 v80, v43, v44, v80
    v_min3_f32 v81, v43, v44, v81
    v_max3_f32 v80, v45, v46, v80
    v_min3_f32 v81, v45, v46, v81
    v_max_f32 v80, v47, v80
    v_min_f32 v81, v47, v81
    v_mov_b32 v82, v80
    v_mov_b32 v83, v81
    v_mul_f32 v88, s84, v180
    v_permlane32_swap_b32 v80, v82
    v_permlane32_swap_b32 v81, v83
    v_max_f32 v80, v80, v82
    v_min_f32 v81, v81, v83
    v_mul_f32 v80, v80, v88
    v_mul_f32 v81, v81, v88
    v_pk_fma_f32 v[64:65], v[32:33], v[88:89], v[80:81] op_sel:[0,0,1] op_sel_hi:[1,0,1] neg_lo:[1,0,0] neg_hi:[1,0,0]
    v_pk_fma_f32 v[32:33], v[32:33], v[88:89], v[80:81] op_sel:[0,0,0] op_sel_hi:[1,0,0] neg_lo:[0,0,1] neg_hi:[0,0,1]
    v_pk_fma_f32 v[66:67], v[34:35], v[88:89], v[80:81] op_sel:[0,0,1] op_sel_hi:[1,0,1] neg_lo:[1,0,0] neg_hi:[1,0,0]
    v_pk_fma_f32 v[34:35], v[34:35], v[88:89], v[80:81] op_sel:[0,0,0] op_sel_hi:[1,0,0] neg_lo:[0,0,1] neg_hi:[0,0,1]
    v_pk_fma_f32 v[68:69], v[36:37], v[88:89], v[80:81] op_sel:[0,0,1] op_sel_hi:[1,0,1] neg_lo:[1,0,0] neg_hi:[1,0,0]
    v_pk_fma_f32 v[36:37], v[36:37], v[88:89], v[80:81] op_sel:[0,0,0] op_sel_hi:[1,0,0] neg_lo:[0,0,1] neg_hi:[0,0,1]
    v_pk_fma_f32 v[70:71], v[38:39], v[88:89], v[80:81] op_sel:[0,0,1] op_sel_hi:[1,0,1] neg_lo:[1,0,0] neg_hi:[1,0,0]
    v_pk_fma_f32 v[38:39], v[38:39], v[88:89], v[80:81] op_sel:[0,0,0] op_sel_hi:[1,0,0] neg_lo:[0,0,1] neg_hi:[0,0,1]
    v_pk_fma_f32 v[72:73], v[40:41], v[88:89], v[80:81] op_sel:[0,0,1] op_sel_hi:[1,0,1] neg_lo:[1,0,0] neg_hi:[1,0,0]
    v_pk_fma_f32 v[40:41], v[40:41], v[88:89], v[80:81] op_sel:[0,0,0] op_sel_hi:[1,0,0] neg_lo:[0,0,1] neg_hi:[0,0,1]
    v_pk_fma_f32 v[74:75], v[42:43], v[88:89], v[80:81] op_sel:[0,0,1] op_sel_hi:[1,0,1] neg_lo:[1,0,0] neg_hi:[1,0,0]
    v_pk_fma_f32 v[42:43], v[42:43], v[88:89], v[80:81] op_sel:[0,0,0] op_sel_hi:[1,0,0] neg_lo:[0,0,1] neg_hi:[0,0,1]
    v_pk_fma_f32 v[76:77], v[44:45], v[88:89], v[80:81] op_sel:[0,0,1] op_sel_hi:[1,0,1] neg_lo:[1,0,0] neg_hi:[1,0,0]
    v_pk_fma_f32 v[44:45], v[44:45], v[88:89], v[80:81] op_sel:[0,0,0] op_sel_hi:[1,0,0] neg_lo:[0,0,1] neg_hi:[0,0,1]
    v_pk_fma_f32 v[78:79], v[46:47], v[88:89], v[80:81] op_sel:[0,0,1] op_sel_hi:[1,0,1] neg_lo:[1,0,0] neg_hi:[1,0,0]
    v_pk_fma_f32 v[46:47], v[46:47], v[88:89], v[80:81] op_sel:[0,0,0] op_sel_hi:[1,0,0] neg_lo:[0,0,1] neg_hi:[0,0,1]
    v_exp_f32 v32, v32
    v_exp_f32 v64, v64
    v_exp_f32 v33, v33
    v_exp_f32 v65, v65
    v_exp_f32 v34, v34
    v_exp_f32 v66, v66
    v_exp_f32 v35, v35
    v_exp_f32 v67, v67
    v_exp_f32 v36, v36
    v_exp_f32 v68, v68
    v_exp_f32 v37, v37
    v_exp_f32 v69, v69
    v_exp_f32 v38, v38
    v_exp_f32 v70, v70
    v_exp_f32 v39, v39
    v_exp_f32 v71, v71
    v_exp_f32 v40, v40
    v_exp_f32 v72, v72
    v_exp_f32 v41, v41
    v_exp_f32 v73, v73
    v_exp_f32 v42, v42
    v_exp_f32 v74, v74
    v_exp_f32 v43, v43
    v_exp_f32 v75, v75
    v_exp_f32 v44, v44
    v_exp_f32 v76, v76
    v_exp_f32 v45, v45
    v_exp_f32 v77, v77
    v_exp_f32 v46, v46
    v_exp_f32 v78, v78
    v_exp_f32 v47, v47
    v_exp_f32 v79, v79
    v_pk_add_f32 v[82:83], v[44:45], v[46:47]
    v_pk_add_f32 v[86:87], v[76:77], v[78:79]
    v_pk_fma_f32 v[82:83], v[82:83], v[4:5], v[32:33] op_sel:[0,0,0] op_sel_hi:[1,0,1]
    v_pk_fma_f32 v[86:87], v[86:87], v[4:5], v[64:65] op_sel:[0,0,0] op_sel_hi:[1,0,1]
    v_pk_add_f32 v[82:83], v[82:83], v[34:35]
    v_pk_add_f32 v[86:87], v[86:87], v[66:67]
    v_pk_add_f32 v[82:83], v[82:83], v[36:37]
    v_pk_add_f32 v[86:87], v[86:87], v[68:69]
    v_pk_add_f32 v[82:83], v[82:83], v[38:39]
    v_pk_add_f32 v[86:87], v[86:87], v[70:71]
    v_pk_add_f32 v[82:83], v[82:83], v[40:41]
    v_pk_add_f32 v[86:87], v[86:87], v[72:73]
    v_pk_add_f32 v[82:83], v[82:83], v[42:43]
    v_pk_add_f32 v[86:87], v[86:87], v[74:75]
    v_add_f32 v84, v82, v83
    v_add_f32 v85, v86, v87
    v_mov_b32 v82, v84
    v_mov_b32 v83, v85
    s_nop 0
    v_permlane32_swap_b32 v84, v82
    v_permlane32_swap_b32 v85, v83
    v_add_f32 v84, v84, v82
    v_add_f32 v85, v85, v83
    v_rcp_f32 v86, v84
    v_rcp_f32 v87, v85
    v_mul_f32 v82, v86, v4
    v_mul_f32 v83, v87, v4
    v_pk_mul_f32 v[32:33], v[32:33], v[86:87] op_sel:[0,0] op_sel_hi:[1,0]
    v_pk_mul_f32 v[64:65], v[64:65], v[86:87] op_sel:[0,1] op_sel_hi:[1,1]
    v_pk_mul_f32 v[34:35], v[34:35], v[86:87] op_sel:[0,0] op_sel_hi:[1,0]
    v_pk_mul_f32 v[66:67], v[66:67], v[86:87] op_sel:[0,1] op_sel_hi:[1,1]
    v_pk_mul_f32 v[36:37], v[36:37], v[86:87] op_sel:[0,0] op_sel_hi:[1,0]
    v_pk_mul_f32 v[68:69], v[68:69], v[86:87] op_sel:[0,1] op_sel_hi:[1,1]
    v_pk_mul_f32 v[38:39], v[38:39], v[86:87] op_sel:[0,0] op_sel_hi:[1,0]
    v_pk_mul_f32 v[70:71], v[70:71], v[86:87] op_sel:[0,1] op_sel_hi:[1,1]
    v_pk_mul_f32 v[40:41], v[40:41], v[86:87] op_sel:[0,0] op_sel_hi:[1,0]
    v_pk_mul_f32 v[72:73], v[72:73], v[86:87] op_sel:[0,1] op_sel_hi:[1,1]
    v_pk_mul_f32 v[42:43], v[42:43], v[86:87] op_sel:[0,0] op_sel_hi:[1,0]
    v_pk_mul_f32 v[74:75], v[74:75], v[86:87] op_sel:[0,1] op_sel_hi:[1,1]
    v_pk_mul_f32 v[44:45], v[44:45], v[82:83] op_sel:[0,0] op_sel_hi:[1,0]
    v_pk_mul_f32 v[76:77], v[76:77], v[82:83] op_sel:[0,1] op_sel_hi:[1,1]
    v_pk_mul_f32 v[46:47], v[46:47], v[82:83] op_sel:[0,0] op_sel_hi:[1,0]
    v_pk_mul_f32 v[78:79], v[78:79], v[82:83] op_sel:[0,1] op_sel_hi:[1,1]
    v_cvt_pk_bf16_f32 v96, v32, v33
    v_cvt_pk_bf16_f32 v97, v34, v35
    v_cvt_pk_bf16_f32 v98, v36, v37
    v_cvt_pk_bf16_f32 v99, v38, v39
    v_cvt_pk_bf16_f32 v100, v40, v41
    v_cvt_pk_bf16_f32 v101, v42, v43
    v_cvt_pk_bf16_f32 v102, v44, v45
    v_cvt_pk_bf16_f32 v103, v46, v47
    v_cvt_pk_bf16_f32 v104, v64, v65
    v_cvt_pk_bf16_f32 v105, v66, v67
    v_cvt_pk_bf16_f32 v106, v68, v69
    v_cvt_pk_bf16_f32 v107, v70, v71
    v_cvt_pk_bf16_f32 v108, v72, v73
    v_cvt_pk_bf16_f32 v109, v74, v75
    v_cvt_pk_bf16_f32 v110, v76, v77
    v_cvt_pk_bf16_f32 v111, v78, v79
    ds_write_b64 v17, v[96:97] offset:0
    ds_write_b64 v17, v[104:105] offset:64
    ds_write_b64 v17, v[98:99] offset:16
    ds_write_b64 v17, v[106:107] offset:80
    ds_write_b64 v17, v[100:101] offset:32
    ds_write_b64 v17, v[108:109] offset:96
    ds_write_b64 v17, v[102:103] offset:48
    ds_write_b64 v17, v[110:111] offset:112
    s_waitcnt vmcnt(1)
    s_mov_b64 exec, 1
    ds_add_u32 v31, v11 offset:56
    s_mov_b64 exec, -1
    v_lshrrev_b32 v14, 2, v1
    v_mul_u32_u24 v14, 200, v14
    v_and_b32 v15, 3, v1
    v_lshl_add_u32 v15, v15, 3, v14
    v_add_u32 v15, 126976, v15
    s_lshl_b32 s76, s6, 5
    v_add_u32 v14, s76, v15
L_lw_5:
    ds_read_b32 v13, v31 offset:56
    s_add_u32 s75, s75, 1
    s_waitcnt lgkmcnt(0)
    v_readfirstlane_b32 s80, v13
    s_nop 0
    s_cmp_ge_u32 s80, 4
    s_cbranch_scc1 L_lwd_6
    s_cmp_lt_u32 s75, 200000
    s_cbranch_scc1 L_lw_5
L_lwd_6:
    ds_read_b64_tr_b16 v[64:65], v14 offset:0
    ds_read_b64_tr_b16 v[66:67], v14 offset:3200
    ds_read_b64_tr_b16 v[68:69], v15 offset:128
    ds_read_b64_tr_b16 v[70:71], v15 offset:3328
    ds_read_b64_tr_b16 v[72:73], v15 offset:160
    ds_read_b64_tr_b16 v[74:75], v15 offset:3360
    ds_read_b64_tr_b16 v[76:77], v14 offset:6400
    ds_read_b64_tr_b16 v[78:79], v14 offset:9600
    ds_read_b64_tr_b16 v[80:81], v15 offset:6528
    ds_read_b64_tr_b16 v[82:83], v15 offset:9728
    ds_read_b64_tr_b16 v[84:85], v15 offset:6560
    ds_read_b64_tr_b16 v[86:87], v15 offset:9760
    ds_read_b64_tr_b16 v[88:89], v14 offset:12800
    ds_read_b64_tr_b16 v[90:91], v14 offset:16000
    ds_read_b64_tr_b16 v[92:93], v15 offset:12928
    ds_read_b64_tr_b16 v[94:95], v15 offset:16128
    ds_read_b64_tr_b16 v[96:97], v15 offset:12960
    ds_read_b64_tr_b16 v[98:99], v15 offset:16160
    ds_read_b64_tr_b16 v[100:101], v14 offset:19200
    ds_read_b64_tr_b16 v[102:103], v14 offset:22400
    ds_read_b64_tr_b16 v[104:105], v15 offset:19328
    ds_read_b64_tr_b16 v[106:107], v15 offset:22528
    ds_read_b64_tr_b16 v[108:109], v15 offset:19360
    ds_read_b64_tr_b16 v[110:111], v15 offset:22560
    v_bfe_u32 v16, v1, 4, 1
    v_lshlrev_b32 v16, 5, v16
    v_lshl_add_u32 v16, v3, 4, v16
    v_and_b32 v17, 15, v1
    v_add_lshl_u32 v16, v16, v17, 4
    s_lshl_b32 s76, s96, 2
    s_add_u32 s76, s76, s6
    s_lshl_b32 s70, s76, 14
    s_add_u32 s70, s70, 131072
    s_lshl_b32 s78, s4, 10
    s_add_u32 s77, s70, s78
    s_lshl_b32 s85, s76, 8
    s_waitcnt lgkmcnt(15)
    v_mfma_f32_16x16x32_bf16 v[32:35], v[64:67], v[68:71], 0
    v_mfma_f32_16x16x32_bf16 v[36:39], v[64:67], v[72:75], 0
    s_waitcnt lgkmcnt(12)
    v_mfma_f32_16x16x32_bf16 v[32:35], v[76:79], v[80:83], v[32:35]
    v_mfma_f32_16x16x32_bf16 v[36:39], v[76:79], v[84:87], v[36:39]
    s_waitcnt lgkmcnt(6)
    v_mfma_f32_16x16x32_bf16 v[32:35], v[88:91], v[92:95], v[32:35]
    v_mfma_f32_16x16x32_bf16 v[36:39], v[88:91], v[96:99], v[36:39]
    s_waitcnt lgkmcnt(0)
    v_mfma_f32_16x16x32_bf16 v[32:35], v[100:103], v[104:107], v[32:35]
    v_mfma_f32_16x16x32_bf16 v[36:39], v[100:103], v[108:111], v[36:39]
    s_nop 6
    v_cvt_pk_bf16_f32 v40, v32, v33
    v_cvt_pk_bf16_f32 v41, v34, v35
    v_cvt_pk_bf16_f32 v42, v36, v37
    v_cvt_pk_bf16_f32 v43, v38, v39
    s_nop 0
    v_permlane32_swap_b32 v40, v42
    v_permlane32_swap_b32 v41, v43
    buffer_store_dwordx4 v[40:43], v16, s[40:43], s77 offen sc1
    s_mov_b64 exec, 1
    ds_add_u32 v31, v11 offset:4
    s_mov_b64 exec, -1
    v_mov_b32 v14, 0x00003f80
    v_mov_b32 v15, 0x3f800000
    v_mov_b32 v32, 0
    v_mov_b32 v56, 0
    v_mov_b32 v33, 0
    v_mov_b32 v57, 0
    v_mov_b32 v34, 0
    v_mov_b32 v58, 0
    v_mov_b32 v35, 0
    v_mov_b32 v59, 0
    v_mov_b32 v36, 0
    v_mov_b32 v60, 0
    v_mov_b32 v37, 0
    v_mov_b32 v61, 0
    v_mov_b32 v38, 0
    v_mov_b32 v62, 0
    v_mov_b32 v39, 0
    v_mov_b32 v63, 0
    s_waitcnt vmcnt(1)
    v_mov_b32 v48, v160
    v_mov_b32 v49, v161
    v_mov_b32 v50, v162
    v_mov_b32 v51, v163
    v_mov_b32 v52, v164
    v_mov_b32 v53, v165
    v_mov_b32 v54, v166
    v_mov_b32 v55, v167
    s_lshl_b32 s76, s6, 10
    s_add_u32 s76, s76, 154624
    v_add_u32 v16, s76, v5
    s_mov_b64 exec, 15
L_dbg:
    v_cmp_gt_u32 vcc, 64, v24
    s_cbranch_vccz L_dbgok
    s_sleep 8
    buffer_load_dword v24, v21, s[64:67], 0 offen sc1
    s_add_u32 s75, s75, 1
    s_waitcnt vmcnt(0)
    s_cmp_lt_u32 s75, 200000
    s_cbranch_scc1 L_dbg
L_dbgok:
    s_mov_b64 exec, -1
    s_waitcnt vmcnt(0)
    s_lshr_b32 s78, s4, 3
    s_lshl_b32 s76, s78, 7
    s_xor_b32 s77, s76, 128
    s_add_u32 s76, s76, s85
    s_add_u32 s77, s77, s85
    s_mov_b32 s79, 1
    s_mov_b32 s80, 0
    s_atomic_add s79, s[30:31], s76 glc
    s_atomic_add s80, s[30:31], s77 glc
    s_lshl_b32 s26, s78, 13
    s_xor_b32 s27, s26, 8192
    s_add_u32 s26, s26, s70
    s_add_u32 s27, s27, s70
    s_waitcnt lgkmcnt(0)
    s_add_u32 s79, s79, 1
L_pa:
    s_cmp_ge_u32 s80, 8
    s_cbranch_scc1 L_pa_other
    s_cmp_ge_u32 s79, 8
    s_cbranch_scc1 L_pa_own
    s_mov_b32 s79, 0
    s_mov_b32 s80, 0
    s_atomic_add s79, s[30:31], s76 glc
    s_atomic_add s80, s[30:31], s77 glc
    s_add_u32 s75, s75, 1
    s_waitcnt lgkmcnt(0)
    s_cmp_lt_u32 s75, 200000
    s_cbranch_scc1 L_pa
L_pa_own:
    s_mov_b32 s78, s26
    s_mov_b32 s26, s27
    s_mov_b32 s27, s78
    s_mov_b32 s76, s77
    s_mov_b32 s79, s80
L_pa_other:
    s_mov_b32 s23, s79
    s_cmp_ge_u32 s79, 8
    s_cbranch_scc1 L_pa1
    s_mov_b32 s79, 0
    s_atomic_add s79, s[30:31], s76 glc
L_pa1:
    buffer_load_dwordx4 v[64:67], v5, s[40:43], s27 offen offset:0 sc1
    buffer_load_dwordx4 v[68:71], v5, s[40:43], s27 offen offset:1024 sc1
    buffer_load_dwordx4 v[72:75], v5, s[40:43], s27 offen offset:2048 sc1
    buffer_load_dwordx4 v[76:79], v5, s[40:43], s27 offen offset:3072 sc1
    s_add_u32 s27, s27, 4096
    buffer_load_dwordx4 v[80:83], v5, s[40:43], s27 offen offset:0 sc1
    buffer_load_dwordx4 v[84:87], v5, s[40:43], s27 offen offset:1024 sc1
    buffer_load_dwordx4 v[88:91], v5, s[40:43], s27 offen offset:2048 sc1
    buffer_load_dwordx4 v[92:95], v5, s[40:43], s27 offen offset:3072 sc1
    s_mov_b32 s24, s76
    s_mov_b32 s25, 0
    s_cmp_lg_u32 s25, 0
    s_cbranch_scc1 L_ck_7
    s_cmp_ge_u32 s23, 8
    s_cbranch_scc0 L_cn_8
    buffer_load_dwordx4 v[96:99], v5, s[40:43], s26 offen offset:0 sc1
    buffer_load_dwordx4 v[100:103], v5, s[40:43], s26 offen offset:1024 sc1
    buffer_load_dwordx4 v[104:107], v5, s[40:43], s26 offen offset:2048 sc1
    buffer_load_dwordx4 v[108:111], v5, s[40:43], s26 offen offset:3072 sc1
    s_add_u32 s26, s26, 4096
    buffer_load_dwordx4 v[112:115], v5, s[40:43], s26 offen offset:0 sc1
    buffer_load_dwordx4 v[116:119], v5, s[40:43], s26 offen offset:1024 sc1
    buffer_load_dwordx4 v[120:123], v5, s[40:43], s26 offen offset:2048 sc1
    buffer_load_dwordx4 v[124:127], v5, s[40:43], s26 offen offset:3072 sc1
    s_mov_b32 s25, 1
    s_branch L_ck_7
L_cn_8:
L_ck_7:
    s_cmp_lg_u32 s25, 0
    s_cbranch_scc1 L_ck_9
    s_waitcnt lgkmcnt(0)
    s_cmp_ge_u32 s79, 8
    s_cbranch_scc0 L_cn_10
    buffer_load_dwordx4 v[96:99], v5, s[40:43], s26 offen offset:0 sc1
    buffer_load_dwordx4 v[100:103], v5, s[40:43], s26 offen offset:1024 sc1
    buffer_load_dwordx4 v[104:107], v5, s[40:43], s26 offen offset:2048 sc1
    buffer_load_dwordx4 v[108:111], v5, s[40:43], s26 offen offset:3072 sc1
    s_add_u32 s26, s26, 4096
    buffer_load_dwordx4 v[112:115], v5, s[40:43], s26 offen offset:0 sc1
    buffer_load_dwordx4 v[116:119], v5, s[40:43], s26 offen offset:1024 sc1
    buffer_load_dwordx4 v[120:123], v5, s[40:43], s26 offen offset:2048 sc1
    buffer_load_dwordx4 v[124:127], v5, s[40:43], s26 offen offset:3072 sc1
    s_mov_b32 s25, 1
    s_branch L_ck_9
L_cn_10:
    s_mov_b32 s79, 0
    s_atomic_add s79, s[30:31], s24 glc
L_ck_9:
    s_cmp_lg_u32 s25, 0
    s_cbranch_scc1 L_pa5
    s_waitcnt vmcnt(0)
L_pa5:
    s_waitcnt vmcnt(8)
    v_dot2c_f32_bf16 v32, v64, v14
    v_dot2c_f32_bf16 v33, v64, v15
    v_dot2c_f32_bf16 v34, v65, v14
    v_dot2c_f32_bf16 v35, v65, v15
    v_dot2c_f32_bf16 v36, v66, v14
    v_dot2c_f32_bf16 v37, v66, v15
    v_dot2c_f32_bf16 v38, v67, v14
    v_dot2c_f32_bf16 v39, v67, v15
    v_dot2c_f32_bf16 v32, v68, v14
    v_dot2c_f32_bf16 v33, v68, v15
    v_dot2c_f32_bf16 v34, v69, v14
    v_dot2c_f32_bf16 v35, v69, v15
    v_dot2c_f32_bf16 v36, v70, v14
    v_dot2c_f32_bf16 v37, v70, v15
    v_dot2c_f32_bf16 v38, v71, v14
    v_dot2c_f32_bf16 v39, v71, v15
    v_dot2c_f32_bf16 v32, v72, v14
    v_dot2c_f32_bf16 v33, v72, v15
    v_dot2c_f32_bf16 v34, v73, v14
    v_dot2c_f32_bf16 v35, v73, v15
    v_dot2c_f32_bf16 v36, v74, v14
    v_dot2c_f32_bf16 v37, v74, v15
    v_dot2c_f32_bf16 v38, v75, v14
    v_dot2c_f32_bf16 v39, v75, v15
    v_dot2c_f32_bf16 v32, v76, v14
    v_dot2c_f32_bf16 v33, v76, v15
    v_dot2c_f32_bf16 v34, v77, v14
    v_dot2c_f32_bf16 v35, v77, v15
    v_dot2c_f32_bf16 v36, v78, v14
    v_dot2c_f32_bf16 v37, v78, v15
    v_dot2c_f32_bf16 v38, v79, v14
    v_dot2c_f32_bf16 v39, v79, v15
    v_dot2c_f32_bf16 v32, v80, v14
    v_dot2c_f32_bf16 v33, v80, v15
    v_dot2c_f32_bf16 v34, v81, v14
    v_dot2c_f32_bf16 v35, v81, v15
    v_dot2c_f32_bf16 v36, v82, v14
    v_dot2c_f32_bf16 v37, v82, v15
    v_dot2c_f32_bf16 v38, v83, v14
    v_dot2c_f32_bf16 v39, v83, v15
    v_dot2c_f32_bf16 v32, v84, v14
    v_dot2c_f32_bf16 v33, v84, v15
    v_dot2c_f32_bf16 v34, v85, v14
    v_dot2c_f32_bf16 v35, v85, v15
    v_dot2c_f32_bf16 v36, v86, v14
    v_dot2c_f32_bf16 v37, v86, v15
    v_dot2c_f32_bf16 v38, v87, v14
    v_dot2c_f32_bf16 v39, v87, v15
    v_dot2c_f32_bf16 v32, v88, v14
    v_dot2c_f32_bf16 v33, v88, v15
    v_dot2c_f32_bf16 v34, v89, v14
    v_dot2c_f32_bf16 v35, v89, v15
    v_dot2c_f32_bf16 v36, v90, v14
    v_dot2c_f32_bf16 v37, v90, v15
    v_dot2c_f32_bf16 v38, v91, v14
    v_dot2c_f32_bf16 v39, v91, v15
    v_dot2c_f32_bf16 v32, v92, v14
    v_dot2c_f32_bf16 v33, v92, v15
    v_dot2c_f32_bf16 v34, v93, v14
    v_dot2c_f32_bf16 v35, v93, v15
    v_dot2c_f32_bf16 v36, v94, v14
    v_dot2c_f32_bf16 v37, v94, v15
    v_dot2c_f32_bf16 v38, v95, v14
    v_dot2c_f32_bf16 v39, v95, v15
    s_cmp_lg_u32 s25, 0
    s_cbranch_scc1 L_ck_11
    s_waitcnt lgkmcnt(0)
    s_cmp_ge_u32 s79, 8
    s_cbranch_scc0 L_cn_12
    buffer_load_dwordx4 v[96:99], v5, s[40:43], s26 offen offset:0 sc1
    buffer_load_dwordx4 v[100:103], v5, s[40:43], s26 offen offset:1024 sc1
    buffer_load_dwordx4 v[104:107], v5, s[40:43], s26 offen offset:2048 sc1
    buffer_load_dwordx4 v[108:111], v5, s[40:43], s26 offen offset:3072 sc1
    s_add_u32 s26, s26, 4096
    buffer_load_dwordx4 v[112:115], v5, s[40:43], s26 offen offset:0 sc1
    buffer_load_dwordx4 v[116:119], v5, s[40:43], s26 offen offset:1024 sc1
    buffer_load_dwordx4 v[120:123], v5, s[40:43], s26 offen offset:2048 sc1
    buffer_load_dwordx4 v[124:127], v5, s[40:43], s26 offen offset:3072 sc1
    s_mov_b32 s25, 1
    s_branch L_ck_11
L_cn_12:
    s_mov_b32 s79, 0
    s_atomic_add s79, s[30:31], s24 glc
L_ck_11:
    s_cmp_lg_u32 s25, 0
    s_cbranch_scc1 L_pa2
    s_waitcnt lgkmcnt(0)
    s_cmp_ge_u32 s79, 8
    s_cbranch_scc1 L_pa6
L_poll_13:
    s_mov_b32 s80, 0
    s_atomic_add s80, s[30:31], s24 glc
    s_add_u32 s75, s75, 1
    s_waitcnt lgkmcnt(0)
    s_cmp_ge_u32 s80, 8
    s_cbranch_scc1 L_pdone_14
    s_cmp_lt_u32 s75, 200000
    s_cbranch_scc1 L_poll_13
L_pdone_14:
L_pa6:
    buffer_load_dwordx4 v[96:99], v5, s[40:43], s26 offen offset:0 sc1
    buffer_load_dwordx4 v[100:103], v5, s[40:43], s26 offen offset:1024 sc1
    buffer_load_dwordx4 v[104:107], v5, s[40:43], s26 offen offset:2048 sc1
    buffer_load_dwordx4 v[108:111], v5, s[40:43], s26 offen offset:3072 sc1
    s_add_u32 s26, s26, 4096
    buffer_load_dwordx4 v[112:115], v5, s[40:43], s26 offen offset:0 sc1
    buffer_load_dwordx4 v[116:119], v5, s[40:43], s26 offen offset:1024 sc1
    buffer_load_dwordx4 v[120:123], v5, s[40:43], s26 offen offset:2048 sc1
    buffer_load_dwordx4 v[124:127], v5, s[40:43], s26 offen offset:3072 sc1
L_pa2:
    s_waitcnt vmcnt(7)
    v_dot2c_f32_bf16 v56, v96, v14
    v_dot2c_f32_bf16 v57, v96, v15
    v_dot2c_f32_bf16 v58, v97, v14
    v_dot2c_f32_bf16 v59, v97, v15
    v_dot2c_f32_bf16 v60, v98, v14
    v_dot2c_f32_bf16 v61, v98, v15
    v_dot2c_f32_bf16 v62, v99, v14
    v_dot2c_f32_bf16 v63, v99, v15
    s_waitcnt vmcnt(6)
    v_dot2c_f32_bf16 v56, v100, v14
    v_dot2c_f32_bf16 v57, v100, v15
    v_dot2c_f32_bf16 v58, v101, v14
    v_dot2c_f32_bf16 v59, v101, v15
    v_dot2c_f32_bf16 v60, v102, v14
    v_dot2c_f32_bf16 v61, v102, v15
    v_dot2c_f32_bf16 v62, v103, v14
    v_dot2c_f32_bf16 v63, v103, v15
    s_waitcnt vmcnt(5)
    v_dot2c_f32_bf16 v56, v104, v14
    v_dot2c_f32_bf16 v57, v104, v15
    v_dot2c_f32_bf16 v58, v105, v14
    v_dot2c_f32_bf16 v59, v105, v15
    v_dot2c_f32_bf16 v60, v106, v14
    v_dot2c_f32_bf16 v61, v106, v15
    v_dot2c_f32_bf16 v62, v107, v14
    v_dot2c_f32_bf16 v63, v107, v15
    s_waitcnt vmcnt(4)
    v_dot2c_f32_bf16 v56, v108, v14
    v_dot2c_f32_bf16 v57, v108, v15
    v_dot2c_f32_bf16 v58, v109, v14
    v_dot2c_f32_bf16 v59, v109, v15
    v_dot2c_f32_bf16 v60, v110, v14
    v_dot2c_f32_bf16 v61, v110, v15
    v_dot2c_f32_bf16 v62, v111, v14
    v_dot2c_f32_bf16 v63, v111, v15
    s_waitcnt vmcnt(3)
    v_dot2c_f32_bf16 v56, v112, v14
    v_dot2c_f32_bf16 v57, v112, v15
    v_dot2c_f32_bf16 v58, v113, v14
    v_dot2c_f32_bf16 v59, v113, v15
    v_dot2c_f32_bf16 v60, v114, v14
    v_dot2c_f32_bf16 v61, v114, v15
    v_dot2c_f32_bf16 v62, v115, v14
    v_dot2c_f32_bf16 v63, v115, v15
    s_waitcnt vmcnt(2)
    v_dot2c_f32_bf16 v56, v116, v14
    v_dot2c_f32_bf16 v57, v116, v15
    v_dot2c_f32_bf16 v58, v117, v14
    v_dot2c_f32_bf16 v59, v117, v15
    v_dot2c_f32_bf16 v60, v118, v14
    v_dot2c_f32_bf16 v61, v118, v15
    v_dot2c_f32_bf16 v62, v119, v14
    v_dot2c_f32_bf16 v63, v119, v15
    s_waitcnt vmcnt(1)
    v_dot2c_f32_bf16 v56, v120, v14
    v_dot2c_f32_bf16 v57, v120, v15
    v_dot2c_f32_bf16 v58, v121, v14
    v_dot2c_f32_bf16 v59, v121, v15
    v_dot2c_f32_bf16 v60, v122, v14
    v_dot2c_f32_bf16 v61, v122, v15
    v_dot2c_f32_bf16 v62, v123, v14
    v_dot2c_f32_bf16 v63, v123, v15
    s_waitcnt vmcnt(0)
    v_dot2c_f32_bf16 v56, v124, v14
    v_dot2c_f32_bf16 v57, v124, v15
    v_dot2c_f32_bf16 v58, v125, v14
    v_dot2c_f32_bf16 v59, v125, v15
    v_dot2c_f32_bf16 v60, v126, v14
    v_dot2c_f32_bf16 v61, v126, v15
    v_dot2c_f32_bf16 v62, v127, v14
    v_dot2c_f32_bf16 v63, v127, v15
    v_pk_add_f32 v[32:33], v[32:33], v[56:57]
    v_pk_add_f32 v[34:35], v[34:35], v[58:59]
    v_pk_add_f32 v[36:37], v[36:37], v[60:61]
    v_pk_add_f32 v[38:39], v[38:39], v[62:63]
    v_cvt_pk_bf16_f32 v40, v32, v33
    v_cvt_pk_bf16_f32 v41, v34, v35
    v_cvt_pk_bf16_f32 v42, v36, v37
    v_cvt_pk_bf16_f32 v43, v38, v39
    ds_write_b128 v16, v[40:43]
    s_waitcnt lgkmcnt(0)
    s_setprio 0
    s_barrier
    s_cmp_ge_u32 s5, 14
    s_cbranch_scc1 L_idle
    v_lshlrev_b32 v32, 16, v48
    v_and_b32 v33, 0xffff0000, v48
    v_lshlrev_b32 v34, 16, v49
    v_and_b32 v35, 0xffff0000, v49
    v_lshlrev_b32 v36, 16, v50
    v_and_b32 v37, 0xffff0000, v50
    v_lshlrev_b32 v38, 16, v51
    v_and_b32 v39, 0xffff0000, v51
    v_lshlrev_b32 v40, 16, v52
    v_and_b32 v41, 0xffff0000, v52
    v_lshlrev_b32 v42, 16, v53
    v_and_b32 v43, 0xffff0000, v53
    v_lshlrev_b32 v44, 16, v54
    v_and_b32 v45, 0xffff0000, v54
    v_lshlrev_b32 v46, 16, v55
    v_and_b32 v47, 0xffff0000, v55
    s_lshl_b32 s76, s86, 8
    s_add_u32 s85, s76, 16384
    s_cmp_ge_u32 s69, 3
    s_cselect_b32 s76, 128, 0
    s_add_u32 s85, s85, s76
    s_lshl_b32 s76, s86, 9
    s_lshr_b32 s77, s6, 1
    s_lshl_b32 s77, s77, 8
    s_add_u32 s76, s76, s77
    s_add_u32 s70, s76, 32768
    s_lshl_b32 s76, s86, 15
    s_lshr_b32 s77, s6, 1
    s_lshl_b32 s77, s77, 14
    s_add_u32 s76, s76, s77
    s_add_u32 s71, s76, 2097152
    s_xor_b32 s76, s6, 2
    s_lshl_b32 s76, s76, 12
    s_add_u32 s76, s76, 0
    v_add_u32 v16, s76, v5
    s_lshl_b32 s76, s6, 12
    s_add_u32 s76, s76, 0
    v_add_u32 v17, s76, v5
    s_and_b32 s76, s6, 1
    s_lshl_b32 s76, s76, 2
    v_add_u32 v18, s76, v31
    s_lshr_b32 s76, s6, 1
    s_lshl_b32 s77, s69, 1
    s_add_u32 s76, s76, s77
    s_mul_i32 s77, s86, 14
    s_add_u32 s76, s76, s77
    s_lshl_b32 s88, s76, 11
    s_add_u32 s88, s88, 4194304
    s_lshl_b32 s89, s76, 8
    s_add_u32 s89, s89, 6291456
    v_lshlrev_b32 v19, 3, v1
    v_mov_b32 v22, 0x3f803f80
    v_mov_b32 v28, v18
    v_mov_b32 v29, v19
    s_lshr_b32 s76, s6, 1
    s_lshl_b32 s76, s76, 6
    v_xor_b32 v18, s76, v7
    v_xor_b32 v19, s76, v8
    s_cmp_ge_u32 s6, 2
    s_mov_b32 s78, 0x64275310
    s_cselect_b32 s78, 0xDB9FECA8, s78
    s_bfe_u32 s77, s78, 262144
    s_mul_i32 s77, s77, 3584
    v_add_u32 v24, s77, v18
    v_add_u32 v25, s77, v19
    ds_read_b64_tr_b16 v[128:129], v24 offset:0
    ds_read_b64_tr_b16 v[130:131], v24 offset:1024
    ds_read_b64_tr_b16 v[132:133], v25 offset:0
    ds_read_b64_tr_b16 v[134:135], v25 offset:1024
    ds_read_b64_tr_b16 v[136:137], v24 offset:2048
    ds_read_b64_tr_b16 v[138:139], v24 offset:3072
    ds_read_b64_tr_b16 v[140:141], v25 offset:2048
    ds_read_b64_tr_b16 v[142:143], v25 offset:3072
    s_bfe_u32 s77, s78, 262148
    s_mul_i32 s77, s77, 3584
    v_add_u32 v20, s77, v18
    v_add_u32 v21, s77, v19
    ds_read_b64_tr_b16 v[144:145], v20 offset:0
    ds_read_b64_tr_b16 v[146:147], v20 offset:1024
    ds_read_b64_tr_b16 v[148:149], v21 offset:0
    ds_read_b64_tr_b16 v[150:151], v21 offset:1024
    ds_read_b64_tr_b16 v[152:153], v20 offset:2048
    ds_read_b64_tr_b16 v[154:155], v20 offset:3072
    ds_read_b64_tr_b16 v[156:157], v21 offset:2048
    ds_read_b64_tr_b16 v[158:159], v21 offset:3072
    s_bfe_u32 s77, s78, 262152
    s_mul_i32 s77, s77, 3584
    v_add_u32 v24, s77, v18
    v_add_u32 v25, s77, v19
    ds_read_b64_tr_b16 v[160:161], v24 offset:0
    ds_read_b64_tr_b16 v[162:163], v24 offset:1024
    ds_read_b64_tr_b16 v[164:165], v25 offset:0
    ds_read_b64_tr_b16 v[166:167], v25 offset:1024
    ds_read_b64_tr_b16 v[168:169], v24 offset:2048
    ds_read_b64_tr_b16 v[170:171], v24 offset:3072
    ds_read_b64_tr_b16 v[172:173], v25 offset:2048
    ds_read_b64_tr_b16 v[174:175], v25 offset:3072
    s_bfe_u32 s77, s78, 262156
    s_mul_i32 s77, s77, 3584
    v_add_u32 v20, s77, v18
    v_add_u32 v21, s77, v19
    ds_read_b64_tr_b16 v[176:177], v20 offset:0
    ds_read_b64_tr_b16 v[178:179], v20 offset:1024
    ds_read_b64_tr_b16 v[180:181], v21 offset:0
    ds_read_b64_tr_b16 v[182:183], v21 offset:1024
    ds_read_b64_tr_b16 v[184:185], v20 offset:2048
    ds_read_b64_tr_b16 v[186:187], v20 offset:3072
    ds_read_b64_tr_b16 v[188:189], v21 offset:2048
    ds_read_b64_tr_b16 v[190:191], v21 offset:3072
    s_bfe_u32 s77, s78, 262160
    s_mul_i32 s77, s77, 3584
    v_add_u32 v24, s77, v18
    v_add_u32 v25, s77, v19
    ds_read_b64_tr_b16 v[192:193], v24 offset:0
    ds_read_b64_tr_b16 v[194:195], v24 offset:1024
    ds_read_b64_tr_b16 v[196:197], v25 offset:0
    ds_read_b64_tr_b16 v[198:199], v25 offset:1024
    ds_read_b64_tr_b16 v[200:201], v24 offset:2048
    ds_read_b64_tr_b16 v[202:203], v24 offset:3072
    ds_read_b64_tr_b16 v[204:205], v25 offset:2048
    ds_read_b64_tr_b16 v[206:207], v25 offset:3072
    s_bfe_u32 s77, s78, 262164
    s_mul_i32 s77, s77, 3584
    v_add_u32 v20, s77, v18
    v_add_u32 v21, s77, v19
    ds_read_b64_tr_b16 v[208:209], v20 offset:0
    ds_read_b64_tr_b16 v[210:211], v20 offset:1024
    ds_read_b64_tr_b16 v[212:213], v21 offset:0
    ds_read_b64_tr_b16 v[214:215], v21 offset:1024
    ds_read_b64_tr_b16 v[216:217], v20 offset:2048
    ds_read_b64_tr_b16 v[218:219], v20 offset:3072
    ds_read_b64_tr_b16 v[220:221], v21 offset:2048
    ds_read_b64_tr_b16 v[222:223], v21 offset:3072
    s_bfe_u32 s77, s78, 262168
    s_mul_i32 s77, s77, 3584
    v_add_u32 v24, s77, v18
    v_add_u32 v25, s77, v19
    ds_read_b64_tr_b16 v[224:225], v24 offset:0
    ds_read_b64_tr_b16 v[226:227], v24 offset:1024
    ds_read_b64_tr_b16 v[228:229], v25 offset:0
    ds_read_b64_tr_b16 v[230:231], v25 offset:1024
    ds_read_b64_tr_b16 v[232:233], v24 offset:2048
    ds_read_b64_tr_b16 v[234:235], v24 offset:3072
    ds_read_b64_tr_b16 v[236:237], v25 offset:2048
    ds_read_b64_tr_b16 v[238:239], v25 offset:3072
    s_bfe_u32 s77, s78, 262172
    s_mul_i32 s77, s77, 3584
    v_add_u32 v20, s77, v18
    v_add_u32 v21, s77, v19
    ds_read_b64_tr_b16 v[240:241], v20 offset:0
    ds_read_b64_tr_b16 v[242:243], v20 offset:1024
    ds_read_b64_tr_b16 v[244:245], v21 offset:0
    ds_read_b64_tr_b16 v[246:247], v21 offset:1024
    ds_read_b64_tr_b16 v[248:249], v20 offset:2048
    ds_read_b64_tr_b16 v[250:251], v20 offset:3072
    ds_read_b64_tr_b16 v[252:253], v21 offset:2048
    ds_read_b64_tr_b16 v[254:255], v21 offset:3072
    s_mov_b64 exec, 1
    ds_add_u32 v31, v11 offset:72
    s_mov_b64 exec, -1
    v_mov_b32 v18, v28
    v_mov_b32 v19, v29
L_lw_15:
    ds_read_b32 v13, v31 offset:72
    s_add_u32 s75, s75, 1
    s_waitcnt lgkmcnt(0)
    v_readfirstlane_b32 s80, v13
    s_nop 0
    s_cmp_ge_u32 s80, 4
    s_cbranch_scc1 L_lwd_16
    s_cmp_lt_u32 s75, 200000
    s_cbranch_scc1 L_lw_15
L_lwd_16:
    s_setprio 2
    s_add_u32 s24, s70, 128
    s_mov_b32 s25, 0
L_pb:
    s_mov_b32 s80, 0
    s_mov_b32 s79, 0
    s_atomic_add s80, s[30:31], s70 glc
    s_atomic_add s79, s[30:31], s24 glc
    s_add_u32 s75, s75, 1
    s_waitcnt lgkmcnt(0)
    s_cmp_ge_u32 s80, 4
    s_cbranch_scc1 L_pbd
    s_cmp_lt_u32 s75, 200000
    s_cbranch_scc1 L_pb
L_pbd:
    buffer_load_dwordx4 v[64:67], v5, s[40:43], s71 offen offset:0 sc1
    buffer_load_dwordx4 v[68:71], v5, s[40:43], s71 offen offset:1024 sc1
    buffer_load_dwordx4 v[72:75], v5, s[40:43], s71 offen offset:2048 sc1
    buffer_load_dwordx4 v[76:79], v5, s[40:43], s71 offen offset:3072 sc1
    s_add_u32 s71, s71, 4096
    buffer_load_dwordx4 v[80:83], v5, s[40:43], s71 offen offset:0 sc1
    buffer_load_dwordx4 v[84:87], v5, s[40:43], s71 offen offset:1024 sc1
    buffer_load_dwordx4 v[88:91], v5, s[40:43], s71 offen offset:2048 sc1
    buffer_load_dwordx4 v[92:95], v5, s[40:43], s71 offen offset:3072 sc1
    s_cmp_lg_u32 s25, 0
    s_cbranch_scc1 L_ck_17
    s_waitcnt lgkmcnt(0)
    s_cmp_ge_u32 s79, 4
    s_cbranch_scc0 L_cn_18
    s_add_u32 s71, s71, 4096
    buffer_load_dwordx4 v[96:99], v5, s[40:43], s71 offen offset:0 sc1
    buffer_load_dwordx4 v[100:103], v5, s[40:43], s71 offen offset:1024 sc1
    buffer_load_dwordx4 v[104:107], v5, s[40:43], s71 offen offset:2048 sc1
    buffer_load_dwordx4 v[108:111], v5, s[40:43], s71 offen offset:3072 sc1
    s_add_u32 s71, s71, 4096
    buffer_load_dwordx4 v[112:115], v5, s[40:43], s71 offen offset:0 sc1
    buffer_load_dwordx4 v[116:119], v5, s[40:43], s71 offen offset:1024 sc1
    buffer_load_dwordx4 v[120:123], v5, s[40:43], s71 offen offset:2048 sc1
    buffer_load_dwordx4 v[124:127], v5, s[40:43], s71 offen offset:3072 sc1
    s_mov_b32 s25, 1
    s_branch L_ck_17
L_cn_18:
    s_mov_b32 s79, 0
    s_atomic_add s79, s[30:31], s24 glc
L_ck_17:
    s_cmp_lg_u32 s25, 0
    s_cbranch_scc1 L_ck_19
    s_waitcnt lgkmcnt(0)
    s_cmp_ge_u32 s79, 4
    s_cbranch_scc0 L_cn_20
    s_add_u32 s71, s71, 4096
    buffer_load_dwordx4 v[96:99], v5, s[40:43], s71 offen offset:0 sc1
    buffer_load_dwordx4 v[100:103], v5, s[40:43], s71 offen offset:1024 sc1
    buffer_load_dwordx4 v[104:107], v5, s[40:43], s71 offen offset:2048 sc1
    buffer_load_dwordx4 v[108:111], v5, s[40:43], s71 offen offset:3072 sc1
    s_add_u32 s71, s71, 4096
    buffer_load_dwordx4 v[112:115], v5, s[40:43], s71 offen offset:0 sc1
    buffer_load_dwordx4 v[116:119], v5, s[40:43], s71 offen offset:1024 sc1
    buffer_load_dwordx4 v[120:123], v5, s[40:43], s71 offen offset:2048 sc1
    buffer_load_dwordx4 v[124:127], v5, s[40:43], s71 offen offset:3072 sc1
    s_mov_b32 s25, 1
    s_branch L_ck_19
L_cn_20:
    s_mov_b32 s79, 0
    s_atomic_add s79, s[30:31], s24 glc
L_ck_19:
    s_cmp_lg_u32 s25, 0
    s_cbranch_scc1 L_pb5
    s_waitcnt vmcnt(0)
L_pb5:
    s_waitcnt vmcnt(8)
    v_mfma_f32_32x32x16_bf16 v[48:63], v[132:135], v[64:67], 0
    v_mfma_f32_32x32x16_bf16 v[32:47], v[128:131], v[64:67], v[32:47]
    v_mfma_f32_32x32x16_bf16 v[48:63], v[140:143], v[68:71], v[48:63]
    v_mfma_f32_32x32x16_bf16 v[32:47], v[136:139], v[68:71], v[32:47]
    v_mfma_f32_32x32x16_bf16 v[48:63], v[148:151], v[72:75], v[48:63]
    v_mfma_f32_32x32x16_bf16 v[32:47], v[144:147], v[72:75], v[32:47]
    v_mfma_f32_32x32x16_bf16 v[48:63], v[156:159], v[76:79], v[48:63]
    v_mfma_f32_32x32x16_bf16 v[32:47], v[152:155], v[76:79], v[32:47]
    v_mfma_f32_32x32x16_bf16 v[48:63], v[164:167], v[80:83], v[48:63]
    v_mfma_f32_32x32x16_bf16 v[32:47], v[160:163], v[80:83], v[32:47]
    v_mfma_f32_32x32x16_bf16 v[48:63], v[172:175], v[84:87], v[48:63]
    v_mfma_f32_32x32x16_bf16 v[32:47], v[168:171], v[84:87], v[32:47]
    v_mfma_f32_32x32x16_bf16 v[48:63], v[180:183], v[88:91], v[48:63]
    v_mfma_f32_32x32x16_bf16 v[32:47], v[176:179], v[88:91], v[32:47]
    v_mfma_f32_32x32x16_bf16 v[48:63], v[188:191], v[92:95], v[48:63]
    v_mfma_f32_32x32x16_bf16 v[32:47], v[184:187], v[92:95], v[32:47]
    s_cmp_lg_u32 s25, 0
    s_cbranch_scc1 L_pb2
    s_waitcnt lgkmcnt(0)
    s_cmp_ge_u32 s79, 4
    s_cbranch_scc1 L_pb6
L_poll_21:
    s_mov_b32 s80, 0
    s_atomic_add s80, s[30:31], s24 glc
    s_add_u32 s75, s75, 1
    s_waitcnt lgkmcnt(0)
    s_cmp_ge_u32 s80, 4
    s_cbranch_scc1 L_pdone_22
    s_cmp_lt_u32 s75, 200000
    s_cbranch_scc1 L_poll_21
L_pdone_22:
L_pb6:
    s_add_u32 s71, s71, 4096
    buffer_load_dwordx4 v[96:99], v5, s[40:43], s71 offen offset:0 sc1
    buffer_load_dwordx4 v[100:103], v5, s[40:43], s71 offen offset:1024 sc1
    buffer_load_dwordx4 v[104:107], v5, s[40:43], s71 offen offset:2048 sc1
    buffer_load_dwordx4 v[108:111], v5, s[40:43], s71 offen offset:3072 sc1
    s_add_u32 s71, s71, 4096
    buffer_load_dwordx4 v[112:115], v5, s[40:43], s71 offen offset:0 sc1
    buffer_load_dwordx4 v[116:119], v5, s[40:43], s71 offen offset:1024 sc1
    buffer_load_dwordx4 v[120:123], v5, s[40:43], s71 offen offset:2048 sc1
    buffer_load_dwordx4 v[124:127], v5, s[40:43], s71 offen offset:3072 sc1
L_pb2:
    s_waitcnt vmcnt(7)
    v_mfma_f32_32x32x16_bf16 v[48:63], v[196:199], v[96:99], v[48:63]
    v_mfma_f32_32x32x16_bf16 v[32:47], v[192:195], v[96:99], v[32:47]
    s_waitcnt vmcnt(6)
    v_mfma_f32_32x32x16_bf16 v[48:63], v[204:207], v[100:103], v[48:63]
    v_mfma_f32_32x32x16_bf16 v[32:47], v[200:203], v[100:103], v[32:47]
    s_waitcnt vmcnt(5)
    v_mfma_f32_32x32x16_bf16 v[48:63], v[212:215], v[104:107], v[48:63]
    v_mfma_f32_32x32x16_bf16 v[32:47], v[208:211], v[104:107], v[32:47]
    s_waitcnt vmcnt(4)
    v_mfma_f32_32x32x16_bf16 v[48:63], v[220:223], v[108:111], v[48:63]
    v_mfma_f32_32x32x16_bf16 v[32:47], v[216:219], v[108:111], v[32:47]
    s_waitcnt vmcnt(3)
    v_mfma_f32_32x32x16_bf16 v[48:63], v[228:231], v[112:115], v[48:63]
    s_waitcnt vmcnt(2)
    v_mfma_f32_32x32x16_bf16 v[48:63], v[236:239], v[116:119], v[48:63]
    s_waitcnt vmcnt(1)
    v_mfma_f32_32x32x16_bf16 v[48:63], v[244:247], v[120:123], v[48:63]
    s_waitcnt vmcnt(0)
    v_mfma_f32_32x32x16_bf16 v[48:63], v[252:255], v[124:127], v[48:63]
    v_mfma_f32_32x32x16_bf16 v[32:47], v[224:227], v[112:115], v[32:47]
    v_mfma_f32_32x32x16_bf16 v[32:47], v[232:235], v[116:119], v[32:47]
    s_nop 9
    ds_write_b128 v16, v[48:51] offset:0
    ds_write_b128 v16, v[52:55] offset:1024
    v_mfma_f32_32x32x16_bf16 v[32:47], v[240:243], v[120:123], v[32:47]
    ds_write_b128 v16, v[56:59] offset:2048
    ds_write_b128 v16, v[60:63] offset:3072
    v_mfma_f32_32x32x16_bf16 v[32:47], v[248:251], v[124:127], v[32:47]
    v_mov_b32 v14, 0
    v_mov_b32 v15, 0
    s_mov_b64 exec, 1
    ds_add_u32 v18, v11 offset:8
    s_mov_b64 exec, -1
L_lw_23:
    ds_read_b32 v13, v18 offset:8
    s_add_u32 s75, s75, 1
    s_waitcnt lgkmcnt(0)
    v_readfirstlane_b32 s80, v13
    s_nop 0
    s_cmp_ge_u32 s80, 2
    s_cbranch_scc1 L_lwd_24
    s_cmp_lt_u32 s75, 200000
    s_cbranch_scc1 L_lw_23
L_lwd_24:
    ds_read_b128 v[48:51], v17 offset:0
    ds_read_b128 v[52:55], v17 offset:1024
    ds_read_b128 v[56:59], v17 offset:2048
    ds_read_b128 v[60:63], v17 offset:3072
    s_waitcnt lgkmcnt(3)
    v_pk_add_f32 v[32:33], v[32:33], v[48:49]
    v_pk_add_f32 v[34:35], v[34:35], v[50:51]
    v_cvt_pk_bf16_f32 v64, v32, v33
    v_cvt_pk_bf16_f32 v65, v34, v35
    s_waitcnt lgkmcnt(2)
    v_pk_add_f32 v[36:37], v[36:37], v[52:53]
    v_pk_add_f32 v[38:39], v[38:39], v[54:55]
    v_cvt_pk_bf16_f32 v66, v36, v37
    v_cvt_pk_bf16_f32 v67, v38, v39
    s_waitcnt lgkmcnt(1)
    v_pk_add_f32 v[40:41], v[40:41], v[56:57]
    v_pk_add_f32 v[42:43], v[42:43], v[58:59]
    v_cvt_pk_bf16_f32 v68, v40, v41
    v_cvt_pk_bf16_f32 v69, v42, v43
    s_waitcnt lgkmcnt(0)
    v_pk_add_f32 v[44:45], v[44:45], v[60:61]
    v_pk_add_f32 v[46:47], v[46:47], v[62:63]
    v_cvt_pk_bf16_f32 v70, v44, v45
    v_cvt_pk_bf16_f32 v71, v46, v47
    buffer_store_dwordx4 v[64:67], v5, s[40:43], s88 offen sc1
    buffer_store_dwordx4 v[68:71], v5, s[40:43], s88 offen offset:1024 sc1
    v_dot2c_f32_bf16 v14, v64, v22
    v_dot2c_f32_bf16 v15, v64, v64
    v_dot2c_f32_bf16 v14, v65, v22
    v_dot2c_f32_bf16 v15, v65, v65
    v_dot2c_f32_bf16 v14, v66, v22
    v_dot2c_f32_bf16 v15, v66, v66
    v_dot2c_f32_bf16 v14, v67, v22
    v_dot2c_f32_bf16 v15, v67, v67
    v_dot2c_f32_bf16 v14, v68, v22
    v_dot2c_f32_bf16 v15, v68, v68
    v_dot2c_f32_bf16 v14, v69, v22
    v_dot2c_f32_bf16 v15, v69, v69
    v_dot2c_f32_bf16 v14, v70, v22
    v_dot2c_f32_bf16 v15, v70, v70
    v_dot2c_f32_bf16 v14, v71, v22
    v_dot2c_f32_bf16 v15, v71, v71
    s_nop 1
    v_mov_b32 v20, v14
    v_mov_b32 v21, v15
    s_nop 0
    v_permlane32_swap_b32 v14, v20
    v_permlane32_swap_b32 v15, v21
    v_add_f32 v14, v14, v20
    v_add_f32 v15, v15, v21
    s_mov_b32 exec_hi, 0
    buffer_store_dwordx2 v[14:15], v19, s[40:43], s89 offen sc1
    s_mov_b64 exec, -1
    ds_write_b128 v17, v[64:67]
    ds_write_b128 v17, v[68:71] offset:1024
    v_add_u32 v24, 57344, v7
    v_add_u32 v25, 57344, v8
    v_add_u32 v26, 114688, v7
    v_add_u32 v27, 114688, v8
    s_lshl_b32 s76, s4, 2
    s_add_u32 s86, s76, s6
    s_lshl_b32 s76, s86, 8
    s_add_u32 s73, s76, 16384
    s_mul_i32 s70, s86, 28672
    s_add_u32 s70, s70, 4194304
    s_mul_i32 s71, s86, 7168
    s_add_u32 s71, s71, 6291456
    s_mul_i32 s83, s86, 114688
    s_lshl_b32 s76, s5, 13
    s_add_u32 s83, s83, s76
    s_add_u32 s83, s83, 8388608
    v_add_u32 v17, 147456, v5
    s_lshl_b32 s76, s6, 2
    s_add_u32 s76, s76, 163584
    v_mov_b32 v22, s76
    s_lshl_b32 s76, s6, 12
    s_add_u32 s76, s76, 24576
    v_add_u32 v23, s76, v5
    s_lshl_b32 s76, s6, 9
    s_add_u32 s76, s76, 158720
    v_lshlrev_b32 v16, 4, v2
    v_add_u32 v16, s76, v16
    v_mov_b32 v10, 163584
    s_mov_b64 exec, 1
    ds_add_u32 v31, v11 offset:28
    s_mov_b64 exec, -1
    v_lshlrev_b32 v0, 7, v1
    s_waitcnt vmcnt(0)
    s_mov_b64 exec, 1
    buffer_atomic_add v11, off, s[40:43], s85
    s_mov_b64 exec, -1
L_lw_25:
    ds_read_b32 v13, v31 offset:24
    s_add_u32 s75, s75, 1
    s_waitcnt lgkmcnt(0)
    v_readfirstlane_b32 s80, v13
    s_nop 0
    s_cmp_ge_u32 s80, 4
    s_cbranch_scc1 L_lwd_26
    s_cmp_lt_u32 s75, 200000
    s_cbranch_scc1 L_lw_25
L_lwd_26:
    ds_read_b64_tr_b16 v[96:97], v24 offset:0
    ds_read_b64_tr_b16 v[98:99], v24 offset:1024
    ds_read_b64_tr_b16 v[100:101], v25 offset:0
    ds_read_b64_tr_b16 v[102:103], v25 offset:1024
    ds_read_b64_tr_b16 v[104:105], v24 offset:2048
    ds_read_b64_tr_b16 v[106:107], v24 offset:3072
    ds_read_b64_tr_b16 v[108:109], v25 offset:2048
    ds_read_b64_tr_b16 v[110:111], v25 offset:3072
    ds_read_b64_tr_b16 v[112:113], v24 offset:4096
    ds_read_b64_tr_b16 v[114:115], v24 offset:5120
    ds_read_b64_tr_b16 v[116:117], v25 offset:4096
    ds_read_b64_tr_b16 v[118:119], v25 offset:5120
    s_add_u32 s3, s73, 128
L_p2_27:
    s_mov_b32 s80, 0
    s_mov_b32 s79, 0
    s_atomic_add s80, s[30:31], s73 glc
    s_atomic_add s79, s[30:31], s3 glc
    s_add_u32 s75, s75, 1
    s_waitcnt lgkmcnt(0)
    s_cmp_ge_u32 s80, 6
    s_cbranch_scc1 L_p2d_28
    s_cmp_lt_u32 s75, 200000
    s_cbranch_scc1 L_p2_27
L_p2d_28:
    s_cmp_ge_u32 s79, 8
    s_cbranch_scc1 L_p2s_29
    s_mov_b32 s79, 0
    s_atomic_add s79, s[30:31], s3 glc
L_p2s_29:
    buffer_load_dwordx4 v[144:147], v5, s[40:43], s14 offen offset:0 sc1
    buffer_load_dwordx4 v[148:151], v5, s[40:43], s14 offen offset:1024 sc1
    buffer_load_dwordx4 v[152:155], v5, s[40:43], s14 offen offset:2048 sc1
    buffer_load_dwordx4 v[156:159], v5, s[40:43], s14 offen offset:3072 sc1
    buffer_load_dwordx4 v[160:163], v5, s[40:43], s15 offen offset:0 sc1
    buffer_load_dwordx4 v[164:167], v5, s[40:43], s15 offen offset:1024 sc1
    buffer_load_dwordx4 v[168:171], v5, s[40:43], s15 offen offset:2048 sc1
    buffer_load_dwordx4 v[172:175], v5, s[40:43], s15 offen offset:3072 sc1
    buffer_load_dwordx4 v[176:179], v5, s[40:43], s16 offen offset:0 sc1
    buffer_load_dwordx4 v[180:183], v5, s[40:43], s16 offen offset:1024 sc1
    buffer_load_dwordx4 v[184:187], v5, s[40:43], s16 offen offset:2048 sc1
    buffer_load_dwordx4 v[188:191], v5, s[40:43], s16 offen offset:3072 sc1
    s_waitcnt lgkmcnt(0)
    s_cmp_ge_u32 s79, 8
    s_cbranch_scc1 L_p2f_30
L_poll_31:
    s_mov_b32 s80, 0
    s_atomic_add s80, s[30:31], s3 glc
    s_add_u32 s75, s75, 1
    s_waitcnt lgkmcnt(0)
    s_cmp_ge_u32 s80, 8
    s_cbranch_scc1 L_pdone_32
    s_cmp_lt_u32 s75, 200000
    s_cbranch_scc1 L_poll_31
L_pdone_32:
L_p2f_30:
    s_mov_b64 exec, 1
    ds_add_u32 v22, v11 offset:80
    s_mov_b64 exec, -1
    ds_read_b64_tr_b16 v[120:121], v24 offset:6144
    ds_read_b64_tr_b16 v[122:123], v24 offset:7168
    s_waitcnt vmcnt(11)
    v_mfma_f32_32x32x16_bf16 v[32:47], v[96:99], v[144:147], 0
    buffer_load_dwordx4 v[192:195], v5, s[40:43], s17 offen offset:0 sc1
    ds_read_b64_tr_b16 v[124:125], v25 offset:6144
    ds_read_b64_tr_b16 v[126:127], v25 offset:7168
    v_mfma_f32_32x32x16_bf16 v[48:63], v[100:103], v[144:147], 0
    ds_read_b64_tr_b16 v[96:97], v24 offset:8192
    ds_read_b64_tr_b16 v[98:99], v24 offset:9216
    s_waitcnt vmcnt(11)
    v_mfma_f32_32x32x16_bf16 v[32:47], v[104:107], v[148:151], v[32:47]
    buffer_load_dwordx4 v[196:199], v5, s[40:43], s17 offen offset:1024 sc1
    ds_read_b64_tr_b16 v[100:101], v25 offset:8192
    ds_read_b64_tr_b16 v[102:103], v25 offset:9216
    v_mfma_f32_32x32x16_bf16 v[48:63], v[108:111], v[148:151], v[48:63]
    ds_read_b64_tr_b16 v[104:105], v24 offset:10240
    ds_read_b64_tr_b16 v[106:107], v24 offset:11264
    s_waitcnt vmcnt(11)
    v_mfma_f32_32x32x16_bf16 v[32:47], v[112:115], v[152:155], v[32:47]
    buffer_load_dwordx4 v[200:203], v5, s[40:43], s17 offen offset:2048 sc1
    ds_read_b64_tr_b16 v[108:109], v25 offset:10240
    ds_read_b64_tr_b16 v[110:111], v25 offset:11264
    v_mfma_f32_32x32x16_bf16 v[48:63], v[116:119], v[152:155], v[48:63]
    ds_read_b64_tr_b16 v[112:113], v24 offset:12288
    ds_read_b64_tr_b16 v[114:115], v24 offset:13312
    s_waitcnt vmcnt(11) lgkmcnt(10)
    v_mfma_f32_32x32x16_bf16 v[32:47], v[120:123], v[156:159], v[32:47]
    buffer_load_dwordx4 v[204:207], v5, s[40:43], s17 offen offset:3072 sc1
    ds_read_b64_tr_b16 v[116:117], v25 offset:12288
    ds_read_b64_tr_b16 v[118:119], v25 offset:13312
    v_mfma_f32_32x32x16_bf16 v[48:63], v[124:127], v[156:159], v[48:63]
    ds_read_b64_tr_b16 v[120:121], v24 offset:14336
    ds_read_b64_tr_b16 v[122:123], v24 offset:15360
    s_waitcnt vmcnt(11) lgkmcnt(10)
    v_mfma_f32_32x32x16_bf16 v[32:47], v[96:99], v[160:163], v[32:47]
    buffer_load_dwordx4 v[208:211], v5, s[40:43], s18 offen offset:0 sc1
    ds_read_b64_tr_b16 v[124:125], v25 offset:14336
    ds_read_b64_tr_b16 v[126:127], v25 offset:15360
    v_mfma_f32_32x32x16_bf16 v[48:63], v[100:103], v[160:163], v[48:63]
    ds_read_b64_tr_b16 v[96:97], v24 offset:16384
    ds_read_b64_tr_b16 v[98:99], v24 offset:17408
    s_waitcnt vmcnt(11) lgkmcnt(10)
    v_mfma_f32_32x32x16_bf16 v[32:47], v[104:107], v[164:167], v[32:47]
    buffer_load_dwordx4 v[212:215], v5, s[40:43], s18 offen offset:1024 sc1
    ds_read_b64_tr_b16 v[100:101], v25 offset:16384
    ds_read_b64_tr_b16 v[102:103], v25 offset:17408
    v_mfma_f32_32x32x16_bf16 v[48:63], v[108:111], v[164:167], v[48:63]
    ds_read_b64_tr_b16 v[104:105], v24 offset:18432
    ds_read_b64_tr_b16 v[106:107], v24 offset:19456
    s_waitcnt vmcnt(11) lgkmcnt(10)
    v_mfma_f32_32x32x16_bf16 v[32:47], v[112:115], v[168:171], v[32:47]
    buffer_load_dwordx4 v[216:219], v5, s[40:43], s18 offen offset:2048 sc1
    ds_read_b64_tr_b16 v[108:109], v25 offset:18432
    ds_read_b64_tr_b16 v[110:111], v25 offset:19456
    v_mfma_f32_32x32x16_bf16 v[48:63], v[116:119], v[168:171], v[48:63]
    ds_read_b64_tr_b16 v[112:113], v24 offset:20480
    ds_read_b64_tr_b16 v[114:115], v24 offset:21504
    s_waitcnt vmcnt(11) lgkmcnt(10)
    v_mfma_f32_32x32x16_bf16 v[32:47], v[120:123], v[172:175], v[32:47]
    buffer_load_dwordx4 v[220:223], v5, s[40:43], s18 offen offset:3072 sc1
    ds_read_b64_tr_b16 v[116:117], v25 offset:20480
    ds_read_b64_tr_b16 v[118:119], v25 offset:21504
    v_mfma_f32_32x32x16_bf16 v[48:63], v[124:127], v[172:175], v[48:63]
    ds_read_b64_tr_b16 v[120:121], v24 offset:22528
    ds_read_b64_tr_b16 v[122:123], v24 offset:23552
    s_waitcnt vmcnt(11) lgkmcnt(10)
    v_mfma_f32_32x32x16_bf16 v[32:47], v[96:99], v[176:179], v[32:47]
    buffer_load_dwordx4 v[224:227], v5, s[40:43], s19 offen offset:0 sc1
    ds_read_b64_tr_b16 v[124:125], v25 offset:22528
    ds_read_b64_tr_b16 v[126:127], v25 offset:23552
    v_mfma_f32_32x32x16_bf16 v[48:63], v[100:103], v[176:179], v[48:63]
    ds_read_b64_tr_b16 v[96:97], v24 offset:24576
    ds_read_b64_tr_b16 v[98:99], v24 offset:25600
    s_waitcnt vmcnt(11) lgkmcnt(10)
    v_mfma_f32_32x32x16_bf16 v[32:47], v[104:107], v[180:183], v[32:47]
    buffer_load_dwordx4 v[228:231], v5, s[40:43], s19 offen offset:1024 sc1
    ds_read_b64_tr_b16 v[100:101], v25 offset:24576
    ds_read_b64_tr_b16 v[102:103], v25 offset:25600
    v_mfma_f32_32x32x16_bf16 v[48:63], v[108:111], v[180:183], v[48:63]
    ds_read_b64_tr_b16 v[104:105], v24 offset:26624
    ds_read_b64_tr_b16 v[106:107], v24 offset:27648
    s_waitcnt vmcnt(11) lgkmcnt(10)
    v_mfma_f32_32x32x16_bf16 v[32:47], v[112:115], v[184:187], v[32:47]
    buffer_load_dwordx4 v[232:235], v5, s[40:43], s19 offen offset:2048 sc1
    ds_read_b64_tr_b16 v[108:109], v25 offset:26624
    ds_read_b64_tr_b16 v[110:111], v25 offset:27648
    v_mfma_f32_32x32x16_bf16 v[48:63], v[116:119], v[184:187], v[48:63]
    ds_read_b64_tr_b16 v[112:113], v24 offset:28672
    ds_read_b64_tr_b16 v[114:115], v24 offset:29696
    s_waitcnt vmcnt(11) lgkmcnt(10)
    v_mfma_f32_32x32x16_bf16 v[32:47], v[120:123], v[188:191], v[32:47]
    buffer_load_dwordx4 v[236:239], v5, s[40:43], s19 offen offset:3072 sc1
    ds_read_b64_tr_b16 v[116:117], v25 offset:28672
    ds_read_b64_tr_b16 v[118:119], v25 offset:29696
    v_mfma_f32_32x32x16_bf16 v[48:63], v[124:127], v[188:191], v[48:63]
    ds_read_b64_tr_b16 v[120:121], v24 offset:30720
    ds_read_b64_tr_b16 v[122:123], v24 offset:31744
    s_waitcnt vmcnt(11) lgkmcnt(10)
    v_mfma_f32_32x32x16_bf16 v[32:47], v[96:99], v[192:195], v[32:47]
    buffer_load_dwordx4 v[240:243], v5, s[40:43], s20 offen offset:0 sc1
    ds_read_b64_tr_b16 v[124:125], v25 offset:30720
    ds_read_b64_tr_b16 v[126:127], v25 offset:31744
    v_mfma_f32_32x32x16_bf16 v[48:63], v[100:103], v[192:195], v[48:63]
    ds_read_b64_tr_b16 v[96:97], v24 offset:32768
    ds_read_b64_tr_b16 v[98:99], v24 offset:33792
    s_waitcnt vmcnt(11) lgkmcnt(10)
    v_mfma_f32_32x32x16_bf16 v[32:47], v[104:107], v[196:199], v[32:47]
    buffer_load_dwordx4 v[244:247], v5, s[40:43], s20 offen offset:1024 sc1
    ds_read_b64_tr_b16 v[100:101], v25 offset:32768
    ds_read_b64_tr_b16 v[102:103], v25 offset:33792
    v_mfma_f32_32x32x16_bf16 v[48:63], v[108:111], v[196:199], v[48:63]
    ds_read_b64_tr_b16 v[104:105], v24 offset:34816
    ds_read_b64_tr_b16 v[106:107], v24 offset:35840
    s_waitcnt vmcnt(11) lgkmcnt(10)
    v_mfma_f32_32x32x16_bf16 v[32:47], v[112:115], v[200:203], v[32:47]
    buffer_load_dwordx4 v[248:251], v5, s[40:43], s20 offen offset:2048 sc1
    ds_read_b64_tr_b16 v[108:109], v25 offset:34816
    ds_read_b64_tr_b16 v[110:111], v25 offset:35840
    v_mfma_f32_32x32x16_bf16 v[48:63], v[116:119], v[200:203], v[48:63]
    ds_read_b64_tr_b16 v[112:113], v24 offset:36864
    ds_read_b64_tr_b16 v[114:115], v24 offset:37888
    s_waitcnt vmcnt(11) lgkmcnt(10)
    v_mfma_f32_32x32x16_bf16 v[32:47], v[120:123], v[204:207], v[32:47]
    buffer_load_dwordx4 v[252:255], v5, s[40:43], s20 offen offset:3072 sc1
    ds_read_b64_tr_b16 v[116:117], v25 offset:36864
    ds_read_b64_tr_b16 v[118:119], v25 offset:37888
    v_mfma_f32_32x32x16_bf16 v[48:63], v[124:127], v[204:207], v[48:63]
    ds_read_b64_tr_b16 v[120:121], v24 offset:38912
    ds_read_b64_tr_b16 v[122:123], v24 offset:39936
    s_waitcnt vmcnt(11) lgkmcnt(10)
    v_mfma_f32_32x32x16_bf16 v[32:47], v[96:99], v[208:211], v[32:47]
    ds_read_b64_tr_b16 v[124:125], v25 offset:38912
    ds_read_b64_tr_b16 v[126:127], v25 offset:39936
    v_mfma_f32_32x32x16_bf16 v[48:63], v[100:103], v[208:211], v[48:63]
    ds_read_b64_tr_b16 v[96:97], v24 offset:40960
    ds_read_b64_tr_b16 v[98:99], v24 offset:41984
    s_waitcnt vmcnt(10) lgkmcnt(10)
    v_mfma_f32_32x32x16_bf16 v[32:47], v[104:107], v[212:215], v[32:47]
    ds_read_b64_tr_b16 v[100:101], v25 offset:40960
    ds_read_b64_tr_b16 v[102:103], v25 offset:41984
    v_mfma_f32_32x32x16_bf16 v[48:63], v[108:111], v[212:215], v[48:63]
    ds_read_b64_tr_b16 v[104:105], v24 offset:43008
    ds_read_b64_tr_b16 v[106:107], v24 offset:44032
    s_waitcnt vmcnt(9) lgkmcnt(10)
    v_mfma_f32_32x32x16_bf16 v[32:47], v[112:115], v[216:219], v[32:47]
    ds_read_b64_tr_b16 v[108:109], v25 offset:43008
    ds_read_b64_tr_b16 v[110:111], v25 offset:44032
    v_mfma_f32_32x32x16_bf16 v[48:63], v[116:119], v[216:219], v[48:63]
    ds_read_b64_tr_b16 v[112:113], v24 offset:45056
    ds_read_b64_tr_b16 v[114:115], v24 offset:46080
    s_waitcnt vmcnt(8) lgkmcnt(10)
    v_mfma_f32_32x32x16_bf16 v[32:47], v[120:123], v[220:223], v[32:47]
    ds_read_b64_tr_b16 v[116:117], v25 offset:45056
    ds_read_b64_tr_b16 v[118:119], v25 offset:46080
    v_mfma_f32_32x32x16_bf16 v[48:63], v[124:127], v[220:223], v[48:63]
    ds_read_b64_tr_b16 v[120:121], v24 offset:47104
    ds_read_b64_tr_b16 v[122:123], v24 offset:48128
    s_waitcnt vmcnt(7) lgkmcnt(10)
    v_mfma_f32_32x32x16_bf16 v[32:47], v[96:99], v[224:227], v[32:47]
    ds_read_b64_tr_b16 v[124:125], v25 offset:47104
    ds_read_b64_tr_b16 v[126:127], v25 offset:48128
    v_mfma_f32_32x32x16_bf16 v[48:63], v[100:103], v[224:227], v[48:63]
    ds_read_b64_tr_b16 v[96:97], v24 offset:49152
    ds_read_b64_tr_b16 v[98:99], v24 offset:50176
    s_waitcnt vmcnt(6) lgkmcnt(10)
    v_mfma_f32_32x32x16_bf16 v[32:47], v[104:107], v[228:231], v[32:47]
    ds_read_b64_tr_b16 v[100:101], v24 offset:51200
    ds_read_b64_tr_b16 v[102:103], v24 offset:52224
    v_mfma_f32_32x32x16_bf16 v[48:63], v[108:111], v[228:231], v[48:63]
    ds_read_b32 v13, v22 offset:96
    ds_read_b64_tr_b16 v[104:105], v24 offset:53248
    ds_read_b64_tr_b16 v[106:107], v24 offset:54272
    s_waitcnt vmcnt(5) lgkmcnt(11)
    v_mfma_f32_32x32x16_bf16 v[32:47], v[112:115], v[232:235], v[32:47]
    ds_read_b64_tr_b16 v[108:109], v24 offset:55296
    ds_read_b64_tr_b16 v[110:111], v24 offset:56320
    v_mfma_f32_32x32x16_bf16 v[48:63], v[116:119], v[232:235], v[48:63]
    ds_read_b64_tr_b16 v[112:113], v25 offset:49152
    ds_read_b64_tr_b16 v[114:115], v25 offset:50176
    s_waitcnt vmcnt(4) lgkmcnt(11)
    v_mfma_f32_32x32x16_bf16 v[32:47], v[120:123], v[236:239], v[32:47]
    ds_read_b64_tr_b16 v[116:117], v25 offset:51200
    ds_read_b64_tr_b16 v[118:119], v25 offset:52224
    v_mfma_f32_32x32x16_bf16 v[48:63], v[124:127], v[236:239], v[48:63]
    s_waitcnt lgkmcnt(8)
    v_readfirstlane_b32 s80, v13
    s_nop 0
    s_cmp_ge_u32 s80, 1
    s_cbranch_scc1 L_gcok
L_lw_33:
    ds_read_b32 v13, v22 offset:96
    s_add_u32 s75, s75, 1
    s_waitcnt lgkmcnt(0)
    v_readfirstlane_b32 s80, v13
    s_nop 0
    s_cmp_ge_u32 s80, 1
    s_cbranch_scc1 L_lwd_34
    s_cmp_lt_u32 s75, 200000
    s_cbranch_scc1 L_lw_33
L_lwd_34:
L_gcok:
    ds_read_b128 v[28:31], v16 offset:2048
    ds_read_b128 v[18:21], v16
    ds_read_b128 v[136:139], v17
    ds_read_b128 v[140:143], v17 offset:1024
    ds_read_b64_tr_b16 v[120:121], v25 offset:53248
    ds_read_b64_tr_b16 v[122:123], v25 offset:54272
    s_waitcnt vmcnt(2)
    v_mfma_f32_32x32x16_bf16 v[32:47], v[96:99], v[240:243], v[32:47]
    ds_read_b64_tr_b16 v[124:125], v25 offset:55296
    ds_read_b64_tr_b16 v[126:127], v25 offset:56320
    v_mfma_f32_32x32x16_bf16 v[32:47], v[100:103], v[244:247], v[32:47]
    ds_read_b64_tr_b16 v[96:97], v26 offset:0
    ds_read_b64_tr_b16 v[98:99], v26 offset:1024
    s_waitcnt vmcnt(0) lgkmcnt(14)
    v_mfma_f32_32x32x16_bf16 v[32:47], v[104:107], v[248:251], v[32:47]
    ds_read_b64_tr_b16 v[100:101], v27 offset:0
    ds_read_b64_tr_b16 v[102:103], v27 offset:1024
    v_mfma_f32_32x32x16_bf16 v[32:47], v[108:111], v[252:255], v[32:47]
    s_waitcnt lgkmcnt(8)
    v_mfma_f32_32x32x16_bf16 v[32:47], v[136:139], v[28:31], v[32:47]
    ds_read_b64_tr_b16 v[104:105], v26 offset:2048
    ds_read_b64_tr_b16 v[106:107], v26 offset:3072
    v_mfma_f32_32x32x16_bf16 v[48:63], v[112:115], v[240:243], v[48:63]
    ds_read_b64_tr_b16 v[108:109], v27 offset:2048
    ds_read_b64_tr_b16 v[110:111], v27 offset:3072
    v_mfma_f32_32x32x16_bf16 v[48:63], v[116:119], v[244:247], v[48:63]
    s_nop 5
    ds_write_b128 v23, v[32:35] offset:0
    ds_write_b128 v23, v[36:39] offset:1024
    ds_read_b64_tr_b16 v[112:113], v26 offset:4096
    ds_read_b64_tr_b16 v[114:115], v26 offset:5120
    s_waitcnt lgkmcnt(12)
    v_mfma_f32_32x32x16_bf16 v[48:63], v[120:123], v[248:251], v[48:63]
    ds_write_b128 v23, v[40:43] offset:2048
    ds_write_b128 v23, v[44:47] offset:3072
    ds_read_b64_tr_b16 v[116:117], v27 offset:4096
    ds_read_b64_tr_b16 v[118:119], v27 offset:5120
    v_mfma_f32_32x32x16_bf16 v[48:63], v[124:127], v[252:255], v[48:63]
    s_mov_b64 exec, 1
    ds_add_u32 v22, v11 offset:32
    s_mov_b64 exec, -1
    v_mfma_f32_32x32x16_bf16 v[48:63], v[140:143], v[28:31], v[48:63]
    s_mov_b64 exec, 1
    ds_add_u32 v10, v11 offset:48
    s_mov_b64 exec, -1
    s_nop 8
    v_pk_mul_f32 v[128:129], v[48:49], v[48:49]
    v_pk_mul_f32 v[130:131], v[50:51], v[50:51]
    v_pk_mul_f32 v[132:133], v[52:53], v[52:53]
    v_pk_mul_f32 v[134:135], v[54:55], v[54:55]
    v_pk_fma_f32 v[128:129], v[128:129], v[18:19], v[18:19] op_sel:[0,1,0] op_sel_hi:[1,1,0]
    v_pk_fma_f32 v[130:131], v[130:131], v[18:19], v[18:19] op_sel:[0,1,0] op_sel_hi:[1,1,0]
    v_pk_fma_f32 v[132:133], v[132:133], v[18:19], v[18:19] op_sel:[0,1,0] op_sel_hi:[1,1,0]
    v_pk_fma_f32 v[134:135], v[134:135], v[18:19], v[18:19] op_sel:[0,1,0] op_sel_hi:[1,1,0]
    v_pk_mul_f32 v[128:129], v[128:129], v[48:49]
    v_pk_mul_f32 v[130:131], v[130:131], v[50:51]
    v_pk_mul_f32 v[132:133], v[132:133], v[52:53]
    v_pk_mul_f32 v[134:135], v[134:135], v[54:55]
    v_exp_f32 v128, v128
    v_exp_f32 v129, v129
    v_exp_f32 v130, v130
    v_exp_f32 v131, v131
    v_exp_f32 v132, v132
    v_exp_f32 v133, v133
    v_exp_f32 v134, v134
    v_exp_f32 v135, v135
    v_pk_fma_f32 v[128:129], v[128:129], v[20:21], v[20:21] op_sel:[0,0,0] op_sel_hi:[1,0,0]
    v_pk_fma_f32 v[130:131], v[130:131], v[20:21], v[20:21] op_sel:[0,0,0] op_sel_hi:[1,0,0]
    v_pk_fma_f32 v[132:133], v[132:133], v[20:21], v[20:21] op_sel:[0,0,0] op_sel_hi:[1,0,0]
    v_pk_fma_f32 v[134:135], v[134:135], v[20:21], v[20:21] op_sel:[0,0,0] op_sel_hi:[1,0,0]
    v_rcp_f32 v128, v128
    v_rcp_f32 v129, v129
    v_rcp_f32 v130, v130
    v_rcp_f32 v131, v131
    v_rcp_f32 v132, v132
    v_rcp_f32 v133, v133
    v_rcp_f32 v134, v134
    v_rcp_f32 v135, v135
    v_pk_mul_f32 v[128:129], v[128:129], v[48:49]
    v_pk_mul_f32 v[130:131], v[130:131], v[50:51]
    v_pk_mul_f32 v[132:133], v[132:133], v[52:53]
    v_pk_mul_f32 v[134:135], v[134:135], v[54:55]
    v_cvt_pk_bf16_f32 v48, v128, v129
    v_cvt_pk_bf16_f32 v49, v130, v131
    v_cvt_pk_bf16_f32 v50, v132, v133
    v_cvt_pk_bf16_f32 v51, v134, v135
    v_pk_mul_f32 v[128:129], v[56:57], v[56:57]
    v_pk_mul_f32 v[130:131], v[58:59], v[58:59]
    v_pk_mul_f32 v[132:133], v[60:61], v[60:61]
    v_pk_mul_f32 v[134:135], v[62:63], v[62:63]
    v_pk_fma_f32 v[128:129], v[128:129], v[18:19], v[18:19] op_sel:[0,1,0] op_sel_hi:[1,1,0]
    v_pk_fma_f32 v[130:131], v[130:131], v[18:19], v[18:19] op_sel:[0,1,0] op_sel_hi:[1,1,0]
    v_pk_fma_f32 v[132:133], v[132:133], v[18:19], v[18:19] op_sel:[0,1,0] op_sel_hi:[1,1,0]
    v_pk_fma_f32 v[134:135], v[134:135], v[18:19], v[18:19] op_sel:[0,1,0] op_sel_hi:[1,1,0]
    v_pk_mul_f32 v[128:129], v[128:129], v[56:57]
    v_pk_mul_f32 v[130:131], v[130:131], v[58:59]
    v_pk_mul_f32 v[132:133], v[132:133], v[60:61]
    v_pk_mul_f32 v[134:135], v[134:135], v[62:63]
    v_exp_f32 v128, v128
    v_exp_f32 v129, v129
    v_exp_f32 v130, v130
    v_exp_f32 v131, v131
    v_exp_f32 v132, v132
    v_exp_f32 v133, v133
    v_exp_f32 v134, v134
    v_exp_f32 v135, v135
    v_pk_fma_f32 v[128:129], v[128:129], v[20:21], v[20:21] op_sel:[0,0,0] op_sel_hi:[1,0,0]
    v_pk_fma_f32 v[130:131], v[130:131], v[20:21], v[20:21] op_sel:[0,0,0] op_sel_hi:[1,0,0]
    v_pk_fma_f32 v[132:133], v[132:133], v[20:21], v[20:21] op_sel:[0,0,0] op_sel_hi:[1,0,0]
    v_pk_fma_f32 v[134:135], v[134:135], v[20:21], v[20:21] op_sel:[0,0,0] op_sel_hi:[1,0,0]
    v_rcp_f32 v128, v128
    v_rcp_f32 v129, v129
    v_rcp_f32 v130, v130
    v_rcp_f32 v131, v131
    v_rcp_f32 v132, v132
    v_rcp_f32 v133, v133
    v_rcp_f32 v134, v134
    v_rcp_f32 v135, v135
    v_pk_mul_f32 v[128:129], v[128:129], v[56:57]
    v_pk_mul_f32 v[130:131], v[130:131], v[58:59]
    v_pk_mul_f32 v[132:133], v[132:133], v[60:61]
    v_pk_mul_f32 v[134:135], v[134:135], v[62:63]
    v_cvt_pk_bf16_f32 v52, v128, v129
    v_cvt_pk_bf16_f32 v53, v130, v131
    v_cvt_pk_bf16_f32 v54, v132, v133
    v_cvt_pk_bf16_f32 v55, v134, v135
    s_add_u32 s76, s83, 2048
    buffer_store_dwordx4 v[48:51], v5, s[40:43], s76 offen sc1
    buffer_store_dwordx4 v[52:55], v5, s[40:43], s76 offen offset:1024 sc1
    ds_read_b128 v[136:139], v17 offset:2048
    ds_read_b128 v[140:143], v17 offset:3072
    ds_read_b64_tr_b16 v[120:121], v26 offset:6144
    ds_read_b64_tr_b16 v[122:123], v26 offset:7168
    s_waitcnt lgkmcnt(15)
    v_mfma_f32_32x32x16_bf16 v[64:79], v[96:99], v[144:147], 0
    ds_read_b64_tr_b16 v[124:125], v27 offset:6144
    ds_read_b64_tr_b16 v[126:127], v27 offset:7168
    v_mfma_f32_32x32x16_bf16 v[80:95], v[100:103], v[144:147], 0
    ds_read_b64_tr_b16 v[96:97], v26 offset:8192
    ds_read_b64_tr_b16 v[98:99], v26 offset:9216
    s_waitcnt lgkmcnt(15)
    v_mfma_f32_32x32x16_bf16 v[64:79], v[104:107], v[148:151], v[64:79]
    ds_read_b64_tr_b16 v[100:101], v27 offset:8192
    ds_read_b64_tr_b16 v[102:103], v27 offset:9216
    v_mfma_f32_32x32x16_bf16 v[80:95], v[108:111], v[148:151], v[80:95]
    ds_read_b64_tr_b16 v[104:105], v26 offset:10240
    ds_read_b64_tr_b16 v[106:107], v26 offset:11264
    s_waitcnt lgkmcnt(14)
    v_mfma_f32_32x32x16_bf16 v[64:79], v[112:115], v[152:155], v[64:79]
    ds_read_b64_tr_b16 v[108:109], v27 offset:10240
    ds_read_b64_tr_b16 v[110:111], v27 offset:11264
    v_mfma_f32_32x32x16_bf16 v[80:95], v[116:119], v[152:155], v[80:95]
    ds_read_b64_tr_b16 v[112:113], v26 offset:12288
    ds_read_b64_tr_b16 v[114:115], v26 offset:13312
    s_waitcnt lgkmcnt(10)
    v_mfma_f32_32x32x16_bf16 v[64:79], v[120:123], v[156:159], v[64:79]
    ds_read_b64_tr_b16 v[116:117], v27 offset:12288
    ds_read_b64_tr_b16 v[118:119], v27 offset:13312
    v_mfma_f32_32x32x16_bf16 v[80:95], v[124:127], v[156:159], v[80:95]
    ds_read_b64_tr_b16 v[120:121], v26 offset:14336
    ds_read_b64_tr_b16 v[122:123], v26 offset:15360
    s_waitcnt lgkmcnt(10)
    v_mfma_f32_32x32x16_bf16 v[64:79], v[96:99], v[160:163], v[64:79]
    ds_read_b64_tr_b16 v[124:125], v27 offset:14336
    ds_read_b64_tr_b16 v[126:127], v27 offset:15360
    v_mfma_f32_32x32x16_bf16 v[80:95], v[100:103], v[160:163], v[80:95]
    ds_read_b64_tr_b16 v[96:97], v26 offset:16384
    ds_read_b64_tr_b16 v[98:99], v26 offset:17408
    s_waitcnt lgkmcnt(10)
    v_mfma_f32_32x32x16_bf16 v[64:79], v[104:107], v[164:167], v[64:79]
    ds_read_b64_tr_b16 v[100:101], v27 offset:16384
    ds_read_b64_tr_b16 v[102:103], v27 offset:17408
    v_mfma_f32_32x32x16_bf16 v[80:95], v[108:111], v[164:167], v[80:95]
    ds_read_b64_tr_b16 v[104:105], v26 offset:18432
    ds_read_b64_tr_b16 v[106:107], v26 offset:19456
    s_waitcnt lgkmcnt(10)
    v_mfma_f32_32x32x16_bf16 v[64:79], v[112:115], v[168:171], v[64:79]
    ds_read_b64_tr_b16 v[108:109], v27 offset:18432
    ds_read_b64_tr_b16 v[110:111], v27 offset:19456
    v_mfma_f32_32x32x16_bf16 v[80:95], v[116:119], v[168:171], v[80:95]
    ds_read_b64_tr_b16 v[112:113], v26 offset:20480
    ds_read_b64_tr_b16 v[114:115], v26 offset:21504
    s_waitcnt lgkmcnt(10)
    v_mfma_f32_32x32x16_bf16 v[64:79], v[120:123], v[172:175], v[64:79]
    ds_read_b64_tr_b16 v[116:117], v27 offset:20480
    ds_read_b64_tr_b16 v[118:119], v27 offset:21504
    v_mfma_f32_32x32x16_bf16 v[80:95], v[124:127], v[172:175], v[80:95]
    ds_read_b64_tr_b16 v[120:121], v26 offset:22528
    ds_read_b64_tr_b16 v[122:123], v26 offset:23552
    s_waitcnt lgkmcnt(10)
    v_mfma_f32_32x32x16_bf16 v[64:79], v[96:99], v[176:179], v[64:79]
    ds_read_b64_tr_b16 v[124:125], v27 offset:22528
    ds_read_b64_tr_b16 v[126:127], v27 offset:23552
    v_mfma_f32_32x32x16_bf16 v[80:95], v[100:103], v[176:179], v[80:95]
    ds_read_b64_tr_b16 v[96:97], v26 offset:24576
    ds_read_b64_tr_b16 v[98:99], v26 offset:25600
    s_waitcnt lgkmcnt(10)
    v_mfma_f32_32x32x16_bf16 v[64:79], v[104:107], v[180:183], v[64:79]
    ds_read_b64_tr_b16 v[100:101], v27 offset:24576
    ds_read_b64_tr_b16 v[102:103], v27 offset:25600
    v_mfma_f32_32x32x16_bf16 v[80:95], v[108:111], v[180:183], v[80:95]
    ds_read_b64_tr_b16 v[104:105], v26 offset:26624
    ds_read_b64_tr_b16 v[106:107], v26 offset:27648
    s_waitcnt lgkmcnt(10)
    v_mfma_f32_32x32x16_bf16 v[64:79], v[112:115], v[184:187], v[64:79]
    s_waitcnt vmcnt(0)
    s_mov_b64 exec, 1
    buffer_atomic_add v11, off, s[40:43], s44
    s_mov_b64 exec, -1
    ds_read_b64_tr_b16 v[108:109], v27 offset:26624
    ds_read_b64_tr_b16 v[110:111], v27 offset:27648
    v_mfma_f32_32x32x16_bf16 v[80:95], v[116:119], v[184:187], v[80:95]
    ds_read_b64_tr_b16 v[112:113], v26 offset:28672
    ds_read_b64_tr_b16 v[114:115], v26 offset:29696
    s_waitcnt lgkmcnt(10)
    v_mfma_f32_32x32x16_bf16 v[64:79], v[120:123], v[188:191], v[64:79]
    ds_read_b64_tr_b16 v[116:117], v27 offset:28672
    ds_read_b64_tr_b16 v[118:119], v27 offset:29696
    v_mfma_f32_32x32x16_bf16 v[80:95], v[124:127], v[188:191], v[80:95]
    ds_read_b64_tr_b16 v[120:121], v26 offset:30720
    ds_read_b64_tr_b16 v[122:123], v26 offset:31744
    s_waitcnt lgkmcnt(10)
    v_mfma_f32_32x32x16_bf16 v[64:79], v[96:99], v[192:195], v[64:79]
    ds_read_b64_tr_b16 v[124:125], v27 offset:30720
    ds_read_b64_tr_b16 v[126:127], v27 offset:31744
    v_mfma_f32_32x32x16_bf16 v[80:95], v[100:103], v[192:195], v[80:95]
    ds_read_b64_tr_b16 v[96:97], v7 offset:0
    ds_read_b64_tr_b16 v[98:99], v7 offset:1024
    s_waitcnt lgkmcnt(10)
    v_mfma_f32_32x32x16_bf16 v[64:79], v[104:107], v[196:199], v[64:79]
    s_mov_b64 exec, 1
    ds_add_u32 v10, v11 offset:52
    s_mov_b64 exec, -1
    ds_read_b64_tr_b16 v[100:101], v8 offset:0
    ds_read_b64_tr_b16 v[102:103], v8 offset:1024
    v_mfma_f32_32x32x16_bf16 v[80:95], v[108:111], v[196:199], v[80:95]
    ds_read_b64_tr_b16 v[104:105], v7 offset:2048
    ds_read_b64_tr_b16 v[106:107], v7 offset:3072
    s_waitcnt lgkmcnt(11)
    v_mfma_f32_32x32x16_bf16 v[64:79], v[112:115], v[200:203], v[64:79]
    ds_read_b64_tr_b16 v[108:109], v8 offset:2048
    ds_read_b64_tr_b16 v[110:111], v8 offset:3072
    v_mfma_f32_32x32x16_bf16 v[80:95], v[116:119], v[200:203], v[80:95]
    ds_read_b64_tr_b16 v[112:113], v7 offset:4096
    ds_read_b64_tr_b16 v[114:115], v7 offset:5120
    s_waitcnt lgkmcnt(11)
    v_mfma_f32_32x32x16_bf16 v[64:79], v[120:123], v[204:207], v[64:79]
    ds_read_b64_tr_b16 v[116:117], v8 offset:4096
    ds_read_b64_tr_b16 v[118:119], v8 offset:5120
    v_mfma_f32_32x32x16_bf16 v[80:95], v[124:127], v[204:207], v[80:95]
    ds_read_b64_tr_b16 v[120:121], v7 offset:6144
    ds_read_b64_tr_b16 v[122:123], v7 offset:7168
    s_waitcnt lgkmcnt(10)
    v_mfma_f32_32x32x16_bf16 v[64:79], v[96:99], v[208:211], v[64:79]
    ds_read_b64_tr_b16 v[124:125], v8 offset:6144
    ds_read_b64_tr_b16 v[126:127], v8 offset:7168
    v_mfma_f32_32x32x16_bf16 v[80:95], v[100:103], v[208:211], v[80:95]
    ds_read_b64_tr_b16 v[96:97], v7 offset:8192
    ds_read_b64_tr_b16 v[98:99], v7 offset:9216
    s_waitcnt lgkmcnt(10)
    v_mfma_f32_32x32x16_bf16 v[64:79], v[104:107], v[212:215], v[64:79]
    ds_read_b64_tr_b16 v[100:101], v8 offset:8192
    ds_read_b64_tr_b16 v[102:103], v8 offset:9216
    v_mfma_f32_32x32x16_bf16 v[80:95], v[108:111], v[212:215], v[80:95]
    ds_read_b64_tr_b16 v[104:105], v7 offset:10240
    ds_read_b64_tr_b16 v[106:107], v7 offset:11264
    s_waitcnt lgkmcnt(10)
    v_mfma_f32_32x32x16_bf16 v[64:79], v[112:115], v[216:219], v[64:79]
    ds_read_b64_tr_b16 v[108:109], v8 offset:10240
    ds_read_b64_tr_b16 v[110:111], v8 offset:11264
    v_mfma_f32_32x32x16_bf16 v[80:95], v[116:119], v[216:219], v[80:95]
    ds_read_b64_tr_b16 v[112:113], v7 offset:12288
    ds_read_b64_tr_b16 v[114:115], v7 offset:13312
    s_waitcnt lgkmcnt(10)
    v_mfma_f32_32x32x16_bf16 v[64:79], v[120:123], v[220:223], v[64:79]
    ds_read_b64_tr_b16 v[116:117], v8 offset:12288
    ds_read_b64_tr_b16 v[118:119], v8 offset:13312
    v_mfma_f32_32x32x16_bf16 v[80:95], v[124:127], v[220:223], v[80:95]
    ds_read_b64_tr_b16 v[120:121], v7 offset:14336
    ds_read_b64_tr_b16 v[122:123], v7 offset:15360
    s_waitcnt lgkmcnt(10)
    v_mfma_f32_32x32x16_bf16 v[64:79], v[96:99], v[224:227], v[64:79]
    ds_read_b64_tr_b16 v[124:125], v8 offset:14336
    ds_read_b64_tr_b16 v[126:127], v8 offset:15360
    v_mfma_f32_32x32x16_bf16 v[80:95], v[100:103], v[224:227], v[80:95]
    ds_read_b64_tr_b16 v[96:97], v7 offset:16384
    ds_read_b64_tr_b16 v[98:99], v7 offset:17408
    s_waitcnt lgkmcnt(10)
    v_mfma_f32_32x32x16_bf16 v[64:79], v[104:107], v[228:231], v[64:79]
    ds_read_b64_tr_b16 v[100:101], v7 offset:18432
    ds_read_b64_tr_b16 v[102:103], v7 offset:19456
    v_mfma_f32_32x32x16_bf16 v[80:95], v[108:111], v[228:231], v[80:95]
    s_mov_b64 exec, 1
    ds_add_u32 v10, v11 offset:60
    s_mov_b64 exec, -1
    ds_read_b64_tr_b16 v[104:105], v7 offset:20480
    ds_read_b64_tr_b16 v[106:107], v7 offset:21504
    s_waitcnt lgkmcnt(11)
    v_mfma_f32_32x32x16_bf16 v[64:79], v[112:115], v[232:235], v[64:79]
    ds_read_b64_tr_b16 v[108:109], v7 offset:22528
    ds_read_b64_tr_b16 v[110:111], v7 offset:23552
    v_mfma_f32_32x32x16_bf16 v[80:95], v[116:119], v[232:235], v[80:95]
    ds_read_b64_tr_b16 v[112:113], v8 offset:16384
    ds_read_b64_tr_b16 v[114:115], v8 offset:17408
    s_waitcnt lgkmcnt(11)
    v_mfma_f32_32x32x16_bf16 v[64:79], v[120:123], v[236:239], v[64:79]
    ds_read_b64_tr_b16 v[116:117], v8 offset:18432
    ds_read_b64_tr_b16 v[118:119], v8 offset:19456
    v_mfma_f32_32x32x16_bf16 v[80:95], v[124:127], v[236:239], v[80:95]
    ds_read_b64_tr_b16 v[120:121], v8 offset:20480
    ds_read_b64_tr_b16 v[122:123], v8 offset:21504
    s_waitcnt lgkmcnt(11)
    v_mfma_f32_32x32x16_bf16 v[64:79], v[96:99], v[240:243], v[64:79]
    ds_read_b64_tr_b16 v[124:125], v8 offset:22528
    ds_read_b64_tr_b16 v[126:127], v8 offset:23552
    v_mfma_f32_32x32x16_bf16 v[64:79], v[100:103], v[244:247], v[64:79]
    s_waitcnt lgkmcnt(8)
    v_mfma_f32_32x32x16_bf16 v[64:79], v[104:107], v[248:251], v[64:79]
    v_mfma_f32_32x32x16_bf16 v[64:79], v[108:111], v[252:255], v[64:79]
    v_mfma_f32_32x32x16_bf16 v[64:79], v[136:139], v[28:31], v[64:79]
    s_waitcnt lgkmcnt(4)
    v_mfma_f32_32x32x16_bf16 v[80:95], v[112:115], v[240:243], v[80:95]
    v_mfma_f32_32x32x16_bf16 v[80:95], v[116:119], v[244:247], v[80:95]
    s_waitcnt lgkmcnt(0)
    v_mfma_f32_32x32x16_bf16 v[80:95], v[120:123], v[248:251], v[80:95]
    v_mfma_f32_32x32x16_bf16 v[80:95], v[124:127], v[252:255], v[80:95]
    v_mfma_f32_32x32x16_bf16 v[80:95], v[140:143], v[28:31], v[80:95]
    s_nop 4
    v_pk_mul_f32 v[128:129], v[64:65], v[64:65]
    v_pk_mul_f32 v[130:131], v[66:67], v[66:67]
    v_pk_mul_f32 v[132:133], v[68:69], v[68:69]
    v_pk_mul_f32 v[134:135], v[70:71], v[70:71]
    v_pk_fma_f32 v[128:129], v[128:129], v[18:19], v[18:19] op_sel:[0,1,0] op_sel_hi:[1,1,0]
    v_pk_fma_f32 v[130:131], v[130:131], v[18:19], v[18:19] op_sel:[0,1,0] op_sel_hi:[1,1,0]
    v_pk_fma_f32 v[132:133], v[132:133], v[18:19], v[18:19] op_sel:[0,1,0] op_sel_hi:[1,1,0]
    v_pk_fma_f32 v[134:135], v[134:135], v[18:19], v[18:19] op_sel:[0,1,0] op_sel_hi:[1,1,0]
    v_pk_mul_f32 v[128:129], v[128:129], v[64:65]
    v_pk_mul_f32 v[130:131], v[130:131], v[66:67]
    v_pk_mul_f32 v[132:133], v[132:133], v[68:69]
    v_pk_mul_f32 v[134:135], v[134:135], v[70:71]
    v_exp_f32 v128, v128
    v_exp_f32 v129, v129
    v_exp_f32 v130, v130
    v_exp_f32 v131, v131
    v_exp_f32 v132, v132
    v_exp_f32 v133, v133
    v_exp_f32 v134, v134
    v_exp_f32 v135, v135
    v_pk_fma_f32 v[128:129], v[128:129], v[20:21], v[20:21] op_sel:[0,0,0] op_sel_hi:[1,0,0]
    v_pk_fma_f32 v[130:131], v[130:131], v[20:21], v[20:21] op_sel:[0,0,0] op_sel_hi:[1,0,0]
    v_pk_fma_f32 v[132:133], v[132:133], v[20:21], v[20:21] op_sel:[0,0,0] op_sel_hi:[1,0,0]
    v_pk_fma_f32 v[134:135], v[134:135], v[20:21], v[20:21] op_sel:[0,0,0] op_sel_hi:[1,0,0]
    v_rcp_f32 v128, v128
    v_rcp_f32 v129, v129
    v_rcp_f32 v130, v130
    v_rcp_f32 v131, v131
    v_rcp_f32 v132, v132
    v_rcp_f32 v133, v133
    v_rcp_f32 v134, v134
    v_rcp_f32 v135, v135
    v_pk_mul_f32 v[128:129], v[128:129], v[64:65]
    v_pk_mul_f32 v[130:131], v[130:131], v[66:67]
    v_pk_mul_f32 v[132:133], v[132:133], v[68:69]
    v_pk_mul_f32 v[134:135], v[134:135], v[70:71]
    v_cvt_pk_bf16_f32 v64, v128, v129
    v_cvt_pk_bf16_f32 v65, v130, v131
    v_cvt_pk_bf16_f32 v66, v132, v133
    v_cvt_pk_bf16_f32 v67, v134, v135
    v_pk_mul_f32 v[128:129], v[72:73], v[72:73]
    v_pk_mul_f32 v[130:131], v[74:75], v[74:75]
    v_pk_mul_f32 v[132:133], v[76:77], v[76:77]
    v_pk_mul_f32 v[134:135], v[78:79], v[78:79]
    v_pk_fma_f32 v[128:129], v[128:129], v[18:19], v[18:19] op_sel:[0,1,0] op_sel_hi:[1,1,0]
    v_pk_fma_f32 v[130:131], v[130:131], v[18:19], v[18:19] op_sel:[0,1,0] op_sel_hi:[1,1,0]
    v_pk_fma_f32 v[132:133], v[132:133], v[18:19], v[18:19] op_sel:[0,1,0] op_sel_hi:[1,1,0]
    v_pk_fma_f32 v[134:135], v[134:135], v[18:19], v[18:19] op_sel:[0,1,0] op_sel_hi:[1,1,0]
    v_pk_mul_f32 v[128:129], v[128:129], v[72:73]
    v_pk_mul_f32 v[130:131], v[130:131], v[74:75]
    v_pk_mul_f32 v[132:133], v[132:133], v[76:77]
    v_pk_mul_f32 v[134:135], v[134:135], v[78:79]
    v_exp_f32 v128, v128
    v_exp_f32 v129, v129
    v_exp_f32 v130, v130
    v_exp_f32 v131, v131
    v_exp_f32 v132, v132
    v_exp_f32 v133, v133
    v_exp_f32 v134, v134
    v_exp_f32 v135, v135
    v_pk_fma_f32 v[128:129], v[128:129], v[20:21], v[20:21] op_sel:[0,0,0] op_sel_hi:[1,0,0]
    v_pk_fma_f32 v[130:131], v[130:131], v[20:21], v[20:21] op_sel:[0,0,0] op_sel_hi:[1,0,0]
    v_pk_fma_f32 v[132:133], v[132:133], v[20:21], v[20:21] op_sel:[0,0,0] op_sel_hi:[1,0,0]
    v_pk_fma_f32 v[134:135], v[134:135], v[20:21], v[20:21] op_sel:[0,0,0] op_sel_hi:[1,0,0]
    v_rcp_f32 v128, v128
    v_rcp_f32 v129, v129
    v_rcp_f32 v130, v130
    v_rcp_f32 v131, v131
    v_rcp_f32 v132, v132
    v_rcp_f32 v133, v133
    v_rcp_f32 v134, v134
    v_rcp_f32 v135, v135
    v_pk_mul_f32 v[128:129], v[128:129], v[72:73]
    v_pk_mul_f32 v[130:131], v[130:131], v[74:75]
    v_pk_mul_f32 v[132:133], v[132:133], v[76:77]
    v_pk_mul_f32 v[134:135], v[134:135], v[78:79]
    v_cvt_pk_bf16_f32 v68, v128, v129
    v_cvt_pk_bf16_f32 v69, v130, v131
    v_cvt_pk_bf16_f32 v70, v132, v133
    v_cvt_pk_bf16_f32 v71, v134, v135
    s_add_u32 s76, s83, 4096
    buffer_store_dwordx4 v[64:67], v5, s[40:43], s76 offen sc1
    buffer_store_dwordx4 v[68:71], v5, s[40:43], s76 offen offset:1024 sc1
    v_mul_f32 v128, v80, v80
    v_mul_f32 v129, v81, v81
    v_mul_f32 v130, v82, v82
    v_mul_f32 v131, v83, v83
    v_fma_f32 v128, v128, v19, v18
    v_fma_f32 v129, v129, v19, v18
    v_fma_f32 v130, v130, v19, v18
    v_fma_f32 v131, v131, v19, v18
    v_mul_f32 v128, v128, v80
    v_mul_f32 v129, v129, v81
    v_mul_f32 v130, v130, v82
    v_mul_f32 v131, v131, v83
    v_exp_f32 v128, v128
    v_exp_f32 v129, v129
    v_exp_f32 v130, v130
    v_exp_f32 v131, v131
    v_fma_f32 v128, v128, v20, v20
    v_fma_f32 v129, v129, v20, v20
    v_fma_f32 v130, v130, v20, v20
    v_fma_f32 v131, v131, v20, v20
    v_rcp_f32 v128, v128
    v_rcp_f32 v129, v129
    v_rcp_f32 v130, v130
    v_rcp_f32 v131, v131
    v_mul_f32 v128, v128, v80
    v_mul_f32 v129, v129, v81
    v_mul_f32 v130, v130, v82
    v_mul_f32 v131, v131, v83
    v_cvt_pk_bf16_f32 v80, v128, v129
    v_cvt_pk_bf16_f32 v81, v130, v131
    v_mul_f32 v132, v84, v84
    v_mul_f32 v133, v85, v85
    v_mul_f32 v134, v86, v86
    v_mul_f32 v135, v87, v87
    v_fma_f32 v132, v132, v19, v18
    v_fma_f32 v133, v133, v19, v18
    v_fma_f32 v134, v134, v19, v18
    v_fma_f32 v135, v135, v19, v18
    v_mul_f32 v132, v132, v84
    v_mul_f32 v133, v133, v85
    v_mul_f32 v134, v134, v86
    v_mul_f32 v135, v135, v87
    v_exp_f32 v132, v132
    v_exp_f32 v133, v133
    v_exp_f32 v134, v134
    v_exp_f32 v135, v135
    v_fma_f32 v132, v132, v20, v20
    v_fma_f32 v133, v133, v20, v20
    v_fma_f32 v134, v134, v20, v20
    v_fma_f32 v135, v135, v20, v20
    v_rcp_f32 v132, v132
    v_rcp_f32 v133, v133
    v_rcp_f32 v134, v134
    v_rcp_f32 v135, v135
    v_mul_f32 v132, v132, v84
    v_mul_f32 v133, v133, v85
    v_mul_f32 v134, v134, v86
    v_mul_f32 v135, v135, v87
    v_cvt_pk_bf16_f32 v82, v132, v133
    v_cvt_pk_bf16_f32 v83, v134, v135
    v_mul_f32 v128, v88, v88
    v_mul_f32 v129, v89, v89
    v_mul_f32 v130, v90, v90
    v_mul_f32 v131, v91, v91
    v_fma_f32 v128, v128, v19, v18
    v_fma_f32 v129, v129, v19, v18
    v_fma_f32 v130, v130, v19, v18
    v_fma_f32 v131, v131, v19, v18
    v_mul_f32 v128, v128, v88
    v_mul_f32 v129, v129, v89
    v_mul_f32 v130, v130, v90
    s_waitcnt vmcnt(0)
    s_mov_b64 exec, 1
    buffer_atomic_add v11, off, s[40:43], s46
    s_mov_b64 exec, -1
    v_mul_f32 v131, v131, v91
    v_exp_f32 v128, v128
    v_exp_f32 v129, v129
    v_exp_f32 v130, v130
    v_exp_f32 v131, v131
    v_fma_f32 v128, v128, v20, v20
    v_fma_f32 v129, v129, v20, v20
    v_fma_f32 v130, v130, v20, v20
    v_fma_f32 v131, v131, v20, v20
    v_rcp_f32 v128, v128
    v_rcp_f32 v129, v129
    v_rcp_f32 v130, v130
    v_rcp_f32 v131, v131
    v_mul_f32 v128, v128, v88
    v_mul_f32 v129, v129, v89
    v_mul_f32 v130, v130, v90
    v_mul_f32 v131, v131, v91
    v_cvt_pk_bf16_f32 v84, v128, v129
    v_cvt_pk_bf16_f32 v85, v130, v131
    v_mul_f32 v132, v92, v92
    v_mul_f32 v133, v93, v93
    v_mul_f32 v134, v94, v94
    v_mul_f32 v135, v95, v95
    v_fma_f32 v132, v132, v19, v18
    v_fma_f32 v133, v133, v19, v18
    v_fma_f32 v134, v134, v19, v18
    v_fma_f32 v135, v135, v19, v18
    v_mul_f32 v132, v132, v92
    v_mul_f32 v133, v133, v93
    v_mul_f32 v134, v134, v94
    v_mul_f32 v135, v135, v95
    v_exp_f32 v132, v132
    v_exp_f32 v133, v133
    v_exp_f32 v134, v134
    v_exp_f32 v135, v135
    v_fma_f32 v132, v132, v20, v20
    v_fma_f32 v133, v133, v20, v20
    v_fma_f32 v134, v134, v20, v20
    v_fma_f32 v135, v135, v20, v20
    v_rcp_f32 v132, v132
    v_rcp_f32 v133, v133
    v_rcp_f32 v134, v134
    v_rcp_f32 v135, v135
    v_mul_f32 v132, v132, v92
    v_mul_f32 v133, v133, v93
    v_mul_f32 v134, v134, v94
    v_mul_f32 v135, v135, v95
    v_cvt_pk_bf16_f32 v86, v132, v133
    v_cvt_pk_bf16_f32 v87, v134, v135
    s_add_u32 s76, s83, 6144
    buffer_store_dwordx4 v[80:83], v5, s[40:43], s76 offen sc1
    buffer_store_dwordx4 v[84:87], v5, s[40:43], s76 offen offset:1024 sc1
    s_waitcnt vmcnt(0)
    s_mov_b64 exec, 1
    buffer_atomic_add v11, off, s[40:43], s45
    s_mov_b64 exec, -1
L_finM:
    s_endpgm
L_H:
    v_and_b32 v0, 255, v0
    s_mov_b32 s60, s12
    s_mov_b32 s61, s13
    s_mov_b32 s62, 25088
    s_mov_b32 s63, 0x00020000
    v_lshrrev_b32 v14, 3, v0
    v_and_b32 v15, 7, v0
    v_min_u32 v15, 6, v15
    v_mul_u32_u24 v16, 56, v14
    v_lshl_add_u32 v16, v15, 3, v16
    v_cmp_gt_u32 vcc, 28, v14
    v_mov_b32 v15, 0x100000
    s_nop 0
    v_cndmask_b32 v141, v15, v16, vcc
    s_mov_b32 s44, s14
    s_mov_b32 s45, s15
    s_mov_b32 s46, 401408
    s_mov_b32 s47, 0x00020000
    s_mov_b32 s48, s18
    s_mov_b32 s49, s19
    s_mov_b32 s50, 1605632
    s_mov_b32 s51, 0x00020000
    s_mov_b32 s52, s22
    s_mov_b32 s53, s23
    s_mov_b32 s54, 1605632
    s_mov_b32 s55, 0x00020000
    s_mov_b32 s56, s26
    s_mov_b32 s57, s27
    s_mov_b32 s58, 1835008
    s_mov_b32 s59, 0x00020000
    v_mov_b32 v14, 0
    v_lshl_add_u32 v15, v2, 2, v31
    ds_write_b32 v15, v14
    v_mov_b32 v32, 0x3f803f80
    v_mov_b32 v33, 0x3f803f80
    v_mov_b32 v34, 0x3f803f80
    v_mov_b32 v35, 0x3f803f80
    v_mov_b32 v36, 0
    v_mov_b32 v37, 0
    v_mov_b32 v17, v19
    v_add_u32 v19, s73, v6
    s_lshr_b32 s76, s6, 1
    s_lshl_b32 s76, s76, 9
    s_and_b32 s77, s6, 1
    s_lshl_b32 s77, s77, 3
    s_add_u32 s76, s76, s77
    v_lshlrev_b32 v18, 4, v2
    v_add_u32 v18, s76, v18
    s_mov_b32 s98, s20
    s_mov_b32 s99, s21
    s_mul_i32 s28, s97, 7
    s_add_u32 s28, s28, 1
    s_lshr_b32 s28, s28, 1
    s_add_u32 s76, s6, 0
    s_mul_i32 s79, s76, 74
    s_lshr_b32 s79, s79, 10
    s_mul_i32 s80, s79, 14
    s_sub_u32 s76, s76, s80
    s_add_u32 s76, s76, s28
    s_sub_u32 s80, s76, 14
    s_min_u32 s76, s76, s80
    s_lshl_b32 s76, s76, 2
    s_add_u32 s76, s76, s79
    s_lshl_b32 s8, s76, 11
    s_add_u32 s76, s6, 4
    s_mul_i32 s79, s76, 74
    s_lshr_b32 s79, s79, 10
    s_mul_i32 s80, s79, 14
    s_sub_u32 s76, s76, s80
    s_add_u32 s76, s76, s28
    s_sub_u32 s80, s76, 14
    s_min_u32 s76, s76, s80
    s_lshl_b32 s76, s76, 2
    s_add_u32 s76, s76, s79
    s_lshl_b32 s9, s76, 11
    s_add_u32 s76, s6, 8
    s_mul_i32 s79, s76, 74
    s_lshr_b32 s79, s79, 10
    s_mul_i32 s80, s79, 14
    s_sub_u32 s76, s76, s80
    s_add_u32 s76, s76, s28
    s_sub_u32 s80, s76, 14
    s_min_u32 s76, s76, s80
    s_lshl_b32 s76, s76, 2
    s_add_u32 s76, s76, s79
    s_lshl_b32 s10, s76, 11
    s_add_u32 s76, s6, 12
    s_mul_i32 s79, s76, 74
    s_lshr_b32 s79, s79, 10
    s_mul_i32 s80, s79, 14
    s_sub_u32 s76, s76, s80
    s_add_u32 s76, s76, s28
    s_sub_u32 s80, s76, 14
    s_min_u32 s76, s76, s80
    s_lshl_b32 s76, s76, 2
    s_add_u32 s76, s76, s79
    s_lshl_b32 s11, s76, 11
    s_add_u32 s76, s6, 16
    s_mul_i32 s79, s76, 74
    s_lshr_b32 s79, s79, 10
    s_mul_i32 s80, s79, 14
    s_sub_u32 s76, s76, s80
    s_add_u32 s76, s76, s28
    s_sub_u32 s80, s76, 14
    s_min_u32 s76, s76, s80
    s_lshl_b32 s76, s76, 2
    s_add_u32 s76, s76, s79
    s_lshl_b32 s12, s76, 11
    s_add_u32 s76, s6, 20
    s_mul_i32 s79, s76, 74
    s_lshr_b32 s79, s79, 10
    s_mul_i32 s80, s79, 14
    s_sub_u32 s76, s76, s80
    s_add_u32 s76, s76, s28
    s_sub_u32 s80, s76, 14
    s_min_u32 s76, s76, s80
    s_lshl_b32 s76, s76, 2
    s_add_u32 s76, s76, s79
    s_lshl_b32 s13, s76, 11
    s_add_u32 s76, s6, 24
    s_mul_i32 s79, s76, 74
    s_lshr_b32 s79, s79, 10
    s_mul_i32 s80, s79, 14
    s_sub_u32 s76, s76, s80
    s_add_u32 s76, s76, s28
    s_sub_u32 s80, s76, 14
    s_min_u32 s76, s76, s80
    s_lshl_b32 s76, s76, 2
    s_add_u32 s76, s76, s79
    s_lshl_b32 s14, s76, 11
    s_add_u32 s76, s6, 28
    s_mul_i32 s79, s76, 74
    s_lshr_b32 s79, s79, 10
    s_mul_i32 s80, s79, 14
    s_sub_u32 s76, s76, s80
    s_add_u32 s76, s76, s28
    s_sub_u32 s80, s76, 14
    s_min_u32 s76, s76, s80
    s_lshl_b32 s76, s76, 2
    s_add_u32 s76, s76, s79
    s_lshl_b32 s15, s76, 11
    s_add_u32 s76, s6, 32
    s_mul_i32 s79, s76, 74
    s_lshr_b32 s79, s79, 10
    s_mul_i32 s80, s79, 14
    s_sub_u32 s76, s76, s80
    s_add_u32 s76, s76, s28
    s_sub_u32 s80, s76, 14
    s_min_u32 s76, s76, s80
    s_lshl_b32 s76, s76, 2
    s_add_u32 s76, s76, s79
    s_lshl_b32 s16, s76, 11
    s_add_u32 s76, s6, 36
    s_mul_i32 s79, s76, 74
    s_lshr_b32 s79, s79, 10
    s_mul_i32 s80, s79, 14
    s_sub_u32 s76, s76, s80
    s_add_u32 s76, s76, s28
    s_sub_u32 s80, s76, 14
    s_min_u32 s76, s76, s80
    s_lshl_b32 s76, s76, 2
    s_add_u32 s76, s76, s79
    s_lshl_b32 s17, s76, 11
    s_add_u32 s76, s6, 40
    s_mul_i32 s79, s76, 74
    s_lshr_b32 s79, s79, 10
    s_mul_i32 s80, s79, 14
    s_sub_u32 s76, s76, s80
    s_add_u32 s76, s76, s28
    s_sub_u32 s80, s76, 14
    s_min_u32 s76, s76, s80
    s_lshl_b32 s76, s76, 2
    s_add_u32 s76, s76, s79
    s_lshl_b32 s18, s76, 11
    s_add_u32 s76, s6, 44
    s_mul_i32 s79, s76, 74
    s_lshr_b32 s79, s79, 10
    s_mul_i32 s80, s79, 14
    s_sub_u32 s76, s76, s80
    s_add_u32 s76, s76, s28
    s_sub_u32 s80, s76, 14
    s_min_u32 s76, s76, s80
    s_lshl_b32 s76, s76, 2
    s_add_u32 s76, s76, s79
    s_lshl_b32 s19, s76, 11
    s_add_u32 s76, s6, 48
    s_mul_i32 s79, s76, 74
    s_lshr_b32 s79, s79, 10
    s_mul_i32 s80, s79, 14
    s_sub_u32 s76, s76, s80
    s_add_u32 s76, s76, s28
    s_sub_u32 s80, s76, 14
    s_min_u32 s76, s76, s80
    s_lshl_b32 s76, s76, 2
    s_add_u32 s76, s76, s79
    s_lshl_b32 s20, s76, 11
    s_add_u32 s76, s6, 52
    s_mul_i32 s79, s76, 74
    s_lshr_b32 s79, s79, 10
    s_mul_i32 s80, s79, 14
    s_sub_u32 s76, s76, s80
    s_add_u32 s76, s76, s28
    s_sub_u32 s80, s76, 14
    s_min_u32 s76, s76, s80
    s_lshl_b32 s76, s76, 2
    s_add_u32 s76, s76, s79
    s_lshl_b32 s21, s76, 11
    s_mul_i32 s79, s96, 1568
    s_mov_b32 s78, s74
    s_add_u32 s7, s7, 2
    s_cmp_ge_u32 s7, 7
    s_cselect_b32 s76, 7, 0
    s_sub_u32 s7, s7, s76
    s_add_u32 s74, s74, 1
    s_cmp_ge_u32 s74, 7
    s_cselect_b32 s76, 7, 0
    s_sub_u32 s74, s74, s76
    s_mul_i32 s77, s74, 172032
    s_add_u32 m0, s73, 8192
    s_add_u32 s77, s77, s71
    s_add_u32 s74, s74, 1
    s_cmp_ge_u32 s74, 7
    s_cselect_b32 s74, 0, s74
    buffer_load_dwordx4 v24, s[36:39], s77 offen lds
    buffer_load_dwordx4 v25, s[36:39], s77 offen offset:1024 lds
    s_lshl_b32 s76, s7, 7
    s_add_u32 s76, s76, s70
    s_add_u32 m0, s72, 32768
    s_add_u32 s7, s7, 1
    s_cmp_ge_u32 s7, 7
    s_cselect_b32 s7, 0, s7
    buffer_load_dwordx4 v20, s[32:35], s76 offen offset:0 lds
    buffer_load_dwordx4 v21, s[32:35], s76 offen offset:1024 lds
    buffer_load_dwordx4 v22, s[32:35], s76 offen offset:2048 lds
    buffer_load_dwordx4 v23, s[32:35], s76 offen offset:3072 lds
    s_waitcnt lgkmcnt(0)
    s_barrier
    ds_read_b128 v[144:147], v26 offset:0
    ds_read_b128 v[148:151], v27 offset:0
    ds_read_b128 v[152:155], v28 offset:0
    ds_read_b128 v[156:159], v29 offset:0
    ds_read_b64_tr_b16 v[80:81], v19 offset:0
    ds_read_b64_tr_b16 v[82:83], v19 offset:256
    ds_read_b64_tr_b16 v[84:85], v19 offset:1024
    ds_read_b64_tr_b16 v[86:87], v19 offset:1280
    ds_read_b128 v[160:163], v26 offset:16384
    ds_read_b128 v[164:167], v27 offset:16384
    ds_read_b128 v[168:171], v28 offset:16384
    ds_read_b128 v[172:175], v29 offset:16384
    s_waitcnt lgkmcnt(4)
    v_mfma_f32_32x32x16_bf16 v[48:63], v[32:35], v[80:83], 0
    v_mfma_f32_32x32x16_bf16 v[64:79], v[32:35], v[84:87], 0
    s_waitcnt lgkmcnt(0)
    v_dot2c_f32_bf16 v36, v144, v32
    v_dot2c_f32_bf16 v37, v144, v144
    v_dot2c_f32_bf16 v36, v145, v32
    v_dot2c_f32_bf16 v37, v145, v145
    v_dot2c_f32_bf16 v36, v146, v32
    v_dot2c_f32_bf16 v37, v146, v146
    v_dot2c_f32_bf16 v36, v147, v32
    v_dot2c_f32_bf16 v37, v147, v147
    v_dot2c_f32_bf16 v36, v148, v32
    v_dot2c_f32_bf16 v37, v148, v148
    v_dot2c_f32_bf16 v36, v149, v32
    v_dot2c_f32_bf16 v37, v149, v149
    v_dot2c_f32_bf16 v36, v150, v32
    v_dot2c_f32_bf16 v37, v150, v150
    v_dot2c_f32_bf16 v36, v151, v32
    v_dot2c_f32_bf16 v37, v151, v151
    v_dot2c_f32_bf16 v36, v152, v32
    v_dot2c_f32_bf16 v37, v152, v152
    v_dot2c_f32_bf16 v36, v153, v32
    v_dot2c_f32_bf16 v37, v153, v153
    v_dot2c_f32_bf16 v36, v154, v32
    v_dot2c_f32_bf16 v37, v154, v154
    v_dot2c_f32_bf16 v36, v155, v32
    v_dot2c_f32_bf16 v37, v155, v155
    v_dot2c_f32_bf16 v36, v156, v32
    v_dot2c_f32_bf16 v37, v156, v156
    v_dot2c_f32_bf16 v36, v157, v32
    v_dot2c_f32_bf16 v37, v157, v157
    v_dot2c_f32_bf16 v36, v158, v32
    v_dot2c_f32_bf16 v37, v158, v158
    v_dot2c_f32_bf16 v36, v159, v32
    v_dot2c_f32_bf16 v37, v159, v159
    v_dot2c_f32_bf16 v36, v160, v32
    v_dot2c_f32_bf16 v37, v160, v160
    v_dot2c_f32_bf16 v36, v161, v32
    v_dot2c_f32_bf16 v37, v161, v161
    v_dot2c_f32_bf16 v36, v162, v32
    v_dot2c_f32_bf16 v37, v162, v162
    v_dot2c_f32_bf16 v36, v163, v32
    v_dot2c_f32_bf16 v37, v163, v163
    v_dot2c_f32_bf16 v36, v164, v32
    v_dot2c_f32_bf16 v37, v164, v164
    v_dot2c_f32_bf16 v36, v165, v32
    v_dot2c_f32_bf16 v37, v165, v165
    v_dot2c_f32_bf16 v36, v166, v32
    v_dot2c_f32_bf16 v37, v166, v166
    v_dot2c_f32_bf16 v36, v167, v32
    v_dot2c_f32_bf16 v37, v167, v167
    v_dot2c_f32_bf16 v36, v168, v32
    v_dot2c_f32_bf16 v37, v168, v168
    v_dot2c_f32_bf16 v36, v169, v32
    v_dot2c_f32_bf16 v37, v169, v169
    v_dot2c_f32_bf16 v36, v170, v32
    v_dot2c_f32_bf16 v37, v170, v170
    v_dot2c_f32_bf16 v36, v171, v32
    v_dot2c_f32_bf16 v37, v171, v171
    v_dot2c_f32_bf16 v36, v172, v32
    v_dot2c_f32_bf16 v37, v172, v172
    v_dot2c_f32_bf16 v36, v173, v32
    v_dot2c_f32_bf16 v37, v173, v173
    v_dot2c_f32_bf16 v36, v174, v32
    v_dot2c_f32_bf16 v37, v174, v174
    v_dot2c_f32_bf16 v36, v175, v32
    v_dot2c_f32_bf16 v37, v175, v175
    s_waitcnt vmcnt(0)
    s_barrier
    ds_read_b64_tr_b16 v[80:81], v19 offset:8192
    ds_read_b64_tr_b16 v[82:83], v19 offset:8448
    ds_read_b64_tr_b16 v[84:85], v19 offset:9216
    ds_read_b64_tr_b16 v[86:87], v19 offset:9472
    ds_read_b128 v[176:179], v26 offset:32768
    ds_read_b128 v[180:183], v27 offset:32768
    ds_read_b128 v[184:187], v28 offset:32768
    ds_read_b128 v[188:191], v29 offset:32768
    buffer_load_dwordx2 v[142:143], v141, s[60:63], s79 offen
    s_waitcnt lgkmcnt(4)
    v_mfma_f32_32x32x16_bf16 v[48:63], v[32:35], v[80:83], v[48:63]
    v_mfma_f32_32x32x16_bf16 v[64:79], v[32:35], v[84:87], v[64:79]
    s_waitcnt lgkmcnt(0)
    v_dot2c_f32_bf16 v36, v176, v32
    v_dot2c_f32_bf16 v37, v176, v176
    v_dot2c_f32_bf16 v36, v177, v32
    v_dot2c_f32_bf16 v37, v177, v177
    v_dot2c_f32_bf16 v36, v178, v32
    v_dot2c_f32_bf16 v37, v178, v178
    v_dot2c_f32_bf16 v36, v179, v32
    v_dot2c_f32_bf16 v37, v179, v179
    v_dot2c_f32_bf16 v36, v180, v32
    v_dot2c_f32_bf16 v37, v180, v180
    v_dot2c_f32_bf16 v36, v181, v32
    v_dot2c_f32_bf16 v37, v181, v181
    v_dot2c_f32_bf16 v36, v182, v32
    v_dot2c_f32_bf16 v37, v182, v182
    v_dot2c_f32_bf16 v36, v183, v32
    v_dot2c_f32_bf16 v37, v183, v183
    v_dot2c_f32_bf16 v36, v184, v32
    v_dot2c_f32_bf16 v37, v184, v184
    v_dot2c_f32_bf16 v36, v185, v32
    v_dot2c_f32_bf16 v37, v185, v185
    v_dot2c_f32_bf16 v36, v186, v32
    v_dot2c_f32_bf16 v37, v186, v186
    v_dot2c_f32_bf16 v36, v187, v32
    v_dot2c_f32_bf16 v37, v187, v187
    v_dot2c_f32_bf16 v36, v188, v32
    v_dot2c_f32_bf16 v37, v188, v188
    v_dot2c_f32_bf16 v36, v189, v32
    v_dot2c_f32_bf16 v37, v189, v189
    v_dot2c_f32_bf16 v36, v190, v32
    v_dot2c_f32_bf16 v37, v190, v190
    v_dot2c_f32_bf16 v36, v191, v32
    v_dot2c_f32_bf16 v37, v191, v191
    s_barrier
    ds_read_b64_tr_b16 v[80:81], v19 offset:16384
    ds_read_b64_tr_b16 v[82:83], v19 offset:16640
    ds_read_b64_tr_b16 v[84:85], v19 offset:17408
    ds_read_b64_tr_b16 v[86:87], v19 offset:17664
    ds_read_b128 v[192:195], v26 offset:49152
    ds_read_b128 v[196:199], v27 offset:49152
    ds_read_b128 v[200:203], v28 offset:49152
    ds_read_b128 v[204:207], v29 offset:49152
    s_mov_b32 s74, s78
    v_mov_b32 v141, v17
    s_waitcnt lgkmcnt(4)
    v_mfma_f32_32x32x16_bf16 v[48:63], v[32:35], v[80:83], v[48:63]
    v_mfma_f32_32x32x16_bf16 v[64:79], v[32:35], v[84:87], v[64:79]
    s_waitcnt lgkmcnt(0)
    v_dot2c_f32_bf16 v36, v192, v32
    v_dot2c_f32_bf16 v37, v192, v192
    v_dot2c_f32_bf16 v36, v193, v32
    v_dot2c_f32_bf16 v37, v193, v193
    v_dot2c_f32_bf16 v36, v194, v32
    v_dot2c_f32_bf16 v37, v194, v194
    v_dot2c_f32_bf16 v36, v195, v32
    v_dot2c_f32_bf16 v37, v195, v195
    v_dot2c_f32_bf16 v36, v196, v32
    v_dot2c_f32_bf16 v37, v196, v196
    v_dot2c_f32_bf16 v36, v197, v32
    v_dot2c_f32_bf16 v37, v197, v197
    v_dot2c_f32_bf16 v36, v198, v32
    v_dot2c_f32_bf16 v37, v198, v198
    v_dot2c_f32_bf16 v36, v199, v32
    v_dot2c_f32_bf16 v37, v199, v199
    v_dot2c_f32_bf16 v36, v200, v32
    v_dot2c_f32_bf16 v37, v200, v200
    v_dot2c_f32_bf16 v36, v201, v32
    v_dot2c_f32_bf16 v37, v201, v201
    v_dot2c_f32_bf16 v36, v202, v32
    v_dot2c_f32_bf16 v37, v202, v202
    v_dot2c_f32_bf16 v36, v203, v32
    v_dot2c_f32_bf16 v37, v203, v203
    v_dot2c_f32_bf16 v36, v204, v32
    v_dot2c_f32_bf16 v37, v204, v204
    v_dot2c_f32_bf16 v36, v205, v32
    v_dot2c_f32_bf16 v37, v205, v205
    v_dot2c_f32_bf16 v36, v206, v32
    v_dot2c_f32_bf16 v37, v206, v206
    v_dot2c_f32_bf16 v36, v207, v32
    v_dot2c_f32_bf16 v37, v207, v207
    s_mul_i32 s76, s2, 1664
    s_cmp_eq_u32 s6, 0
    s_cbranch_scc0 L_t5
    s_mov_b64 exec, 0x1fff
    buffer_load_dword v140, v17, s[44:47], s76 offen
    s_mov_b64 exec, -1
L_t5:
    s_barrier
    ds_read_b64_tr_b16 v[80:81], v19 offset:24576
    ds_read_b64_tr_b16 v[82:83], v19 offset:24832
    ds_read_b64_tr_b16 v[84:85], v19 offset:25600
    ds_read_b64_tr_b16 v[86:87], v19 offset:25856
    v_add_u32 v26, 0x10000, v26
    v_add_u32 v27, 0x10000, v27
    v_add_u32 v28, 0x10000, v28
    v_add_u32 v29, 0x10000, v29
    ds_read_b128 v[208:211], v26 offset:0
    ds_read_b128 v[212:215], v27 offset:0
    ds_read_b128 v[216:219], v28 offset:0
    ds_read_b128 v[220:223], v29 offset:0
    s_waitcnt lgkmcnt(4)
    v_mfma_f32_32x32x16_bf16 v[48:63], v[32:35], v[80:83], v[48:63]
    v_mfma_f32_32x32x16_bf16 v[64:79], v[32:35], v[84:87], v[64:79]
    s_waitcnt lgkmcnt(0)
    v_dot2c_f32_bf16 v36, v208, v32
    v_dot2c_f32_bf16 v37, v208, v208
    v_dot2c_f32_bf16 v36, v209, v32
    v_dot2c_f32_bf16 v37, v209, v209
    v_dot2c_f32_bf16 v36, v210, v32
    v_dot2c_f32_bf16 v37, v210, v210
    v_dot2c_f32_bf16 v36, v211, v32
    v_dot2c_f32_bf16 v37, v211, v211
    v_dot2c_f32_bf16 v36, v212, v32
    v_dot2c_f32_bf16 v37, v212, v212
    v_dot2c_f32_bf16 v36, v213, v32
    v_dot2c_f32_bf16 v37, v213, v213
    v_dot2c_f32_bf16 v36, v214, v32
    v_dot2c_f32_bf16 v37, v214, v214
    v_dot2c_f32_bf16 v36, v215, v32
    v_dot2c_f32_bf16 v37, v215, v215
    v_dot2c_f32_bf16 v36, v216, v32
    v_dot2c_f32_bf16 v37, v216, v216
    v_dot2c_f32_bf16 v36, v217, v32
    v_dot2c_f32_bf16 v37, v217, v217
    v_dot2c_f32_bf16 v36, v218, v32
    v_dot2c_f32_bf16 v37, v218, v218
    v_dot2c_f32_bf16 v36, v219, v32
    v_dot2c_f32_bf16 v37, v219, v219
    v_dot2c_f32_bf16 v36, v220, v32
    v_dot2c_f32_bf16 v37, v220, v220
    v_dot2c_f32_bf16 v36, v221, v32
    v_dot2c_f32_bf16 v37, v221, v221
    v_dot2c_f32_bf16 v36, v222, v32
    v_dot2c_f32_bf16 v37, v222, v222
    v_dot2c_f32_bf16 v36, v223, v32
    v_dot2c_f32_bf16 v37, v223, v223
    s_barrier
    ds_read_b64_tr_b16 v[80:81], v19 offset:32768
    ds_read_b64_tr_b16 v[82:83], v19 offset:33024
    ds_read_b64_tr_b16 v[84:85], v19 offset:33792
    ds_read_b64_tr_b16 v[86:87], v19 offset:34048
    v_subrev_u32 v26, 0x10000, v26
    v_subrev_u32 v27, 0x10000, v27
    v_subrev_u32 v28, 0x10000, v28
    v_subrev_u32 v29, 0x10000, v29
    ds_read_b128 v[224:227], v26 offset:0
    ds_read_b128 v[228:231], v27 offset:0
    ds_read_b128 v[232:235], v28 offset:0
    ds_read_b128 v[236:239], v29 offset:0
    s_waitcnt lgkmcnt(4)
    v_mfma_f32_32x32x16_bf16 v[48:63], v[32:35], v[80:83], v[48:63]
    v_mfma_f32_32x32x16_bf16 v[64:79], v[32:35], v[84:87], v[64:79]
    s_waitcnt lgkmcnt(0)
    v_dot2c_f32_bf16 v36, v224, v32
    v_dot2c_f32_bf16 v37, v224, v224
    v_dot2c_f32_bf16 v36, v225, v32
    v_dot2c_f32_bf16 v37, v225, v225
    v_dot2c_f32_bf16 v36, v226, v32
    v_dot2c_f32_bf16 v37, v226, v226
    v_dot2c_f32_bf16 v36, v227, v32
    v_dot2c_f32_bf16 v37, v227, v227
    v_dot2c_f32_bf16 v36, v228, v32
    v_dot2c_f32_bf16 v37, v228, v228
    v_dot2c_f32_bf16 v36, v229, v32
    v_dot2c_f32_bf16 v37, v229, v229
    v_dot2c_f32_bf16 v36, v230, v32
    v_dot2c_f32_bf16 v37, v230, v230
    v_dot2c_f32_bf16 v36, v231, v32
    v_dot2c_f32_bf16 v37, v231, v231
    v_dot2c_f32_bf16 v36, v232, v32
    v_dot2c_f32_bf16 v37, v232, v232
    v_dot2c_f32_bf16 v36, v233, v32
    v_dot2c_f32_bf16 v37, v233, v233
    v_dot2c_f32_bf16 v36, v234, v32
    v_dot2c_f32_bf16 v37, v234, v234
    v_dot2c_f32_bf16 v36, v235, v32
    v_dot2c_f32_bf16 v37, v235, v235
    v_dot2c_f32_bf16 v36, v236, v32
    v_dot2c_f32_bf16 v37, v236, v236
    v_dot2c_f32_bf16 v36, v237, v32
    v_dot2c_f32_bf16 v37, v237, v237
    v_dot2c_f32_bf16 v36, v238, v32
    v_dot2c_f32_bf16 v37, v238, v238
    v_dot2c_f32_bf16 v36, v239, v32
    v_dot2c_f32_bf16 v37, v239, v239
    s_waitcnt vmcnt(0)
    v_lshlrev_b32 v14, 3, v0
    v_add_u32 v14, 152576, v14
    ds_write_b64 v14, v[142:143]
    s_waitcnt lgkmcnt(0)
    s_barrier
    ds_read_b64_tr_b16 v[80:81], v19 offset:0
    ds_read_b64_tr_b16 v[82:83], v19 offset:256
    ds_read_b64_tr_b16 v[84:85], v19 offset:1024
    ds_read_b64_tr_b16 v[86:87], v19 offset:1280
    ds_read_b128 v[240:243], v26 offset:16384
    ds_read_b128 v[244:247], v27 offset:16384
    ds_read_b128 v[248:251], v28 offset:16384
    ds_read_b128 v[252:255], v29 offset:16384
    s_waitcnt lgkmcnt(4)
    v_mfma_f32_32x32x16_bf16 v[48:63], v[32:35], v[80:83], v[48:63]
    v_mfma_f32_32x32x16_bf16 v[64:79], v[32:35], v[84:87], v[64:79]
    s_waitcnt lgkmcnt(0)
    v_dot2c_f32_bf16 v36, v240, v32
    v_dot2c_f32_bf16 v37, v240, v240
    v_dot2c_f32_bf16 v36, v241, v32
    v_dot2c_f32_bf16 v37, v241, v241
    v_dot2c_f32_bf16 v36, v242, v32
    v_dot2c_f32_bf16 v37, v242, v242
    v_dot2c_f32_bf16 v36, v243, v32
    v_dot2c_f32_bf16 v37, v243, v243
    v_dot2c_f32_bf16 v36, v244, v32
    v_dot2c_f32_bf16 v37, v244, v244
    v_dot2c_f32_bf16 v36, v245, v32
    v_dot2c_f32_bf16 v37, v245, v245
    v_dot2c_f32_bf16 v36, v246, v32
    v_dot2c_f32_bf16 v37, v246, v246
    v_dot2c_f32_bf16 v36, v247, v32
    v_dot2c_f32_bf16 v37, v247, v247
    v_dot2c_f32_bf16 v36, v248, v32
    v_dot2c_f32_bf16 v37, v248, v248
    v_dot2c_f32_bf16 v36, v249, v32
    v_dot2c_f32_bf16 v37, v249, v249
    v_dot2c_f32_bf16 v36, v250, v32
    v_dot2c_f32_bf16 v37, v250, v250
    v_dot2c_f32_bf16 v36, v251, v32
    v_dot2c_f32_bf16 v37, v251, v251
    v_dot2c_f32_bf16 v36, v252, v32
    v_dot2c_f32_bf16 v37, v252, v252
    v_dot2c_f32_bf16 v36, v253, v32
    v_dot2c_f32_bf16 v37, v253, v253
    v_dot2c_f32_bf16 v36, v254, v32
    v_dot2c_f32_bf16 v37, v254, v254
    v_dot2c_f32_bf16 v36, v255, v32
    v_dot2c_f32_bf16 v37, v255, v255
    v_add_u32 v16, 158720, v18
    v_mov_b32 v23, v18
    s_setprio 3
    s_barrier
    ds_read_b64_tr_b16 v[80:81], v19 offset:8192
    ds_read_b64_tr_b16 v[82:83], v19 offset:8448
    ds_read_b64_tr_b16 v[84:85], v19 offset:9216
    ds_read_b64_tr_b16 v[86:87], v19 offset:9472
    v_mov_b32 v14, v36
    v_mov_b32 v15, v37
    s_nop 0
    v_permlane32_swap_b32 v36, v14
    v_permlane32_swap_b32 v37, v15
    v_add_f32 v36, v36, v14
    v_add_f32 v37, v37, v15
    v_mul_f32 v38, 0xbb124925, v36
    v_mul_f32 v14, v38, v38
    v_mov_b32 v15, 0x3b124925
    v_fma_f32 v14, v37, v15, -v14
    v_max_f32 v14, 0, v14
    v_add_f32 v14, 0x3727c5ac, v14
    v_rsq_f32 v42, v14
    v_cvt_pk_bf16_f32 v14, v38, v38
    v_and_b32 v14, 0xffff0000, v14
    v_sub_f32 v14, v38, v14
    v_cvt_pk_bf16_f32 v40, v38, v14
    v_cvt_pk_bf16_f32 v41, v38, 0
    s_lshl_b32 s76, s6, 10
    s_add_u32 s76, s76, 154624
    v_add_u32 v21, s76, v5
    ds_write_b128 v21, v[40:43]
    s_waitcnt lgkmcnt(1)
    v_mfma_f32_32x32x16_bf16 v[48:63], v[32:35], v[80:83], v[48:63]
    v_mfma_f32_32x32x16_bf16 v[64:79], v[32:35], v[84:87], v[64:79]
    s_waitcnt lgkmcnt(0)
    s_lshl_b32 s76, s2, 1
    s_and_b32 s77, s6, 1
    s_add_u32 s76, s76, s77
    s_mul_i32 s76, s76, 3200
    s_mov_b64 exec, 0x1ffffff
    s_cmp_ge_u32 s6, 2
    s_cbranch_scc1 L_t4
    buffer_load_dword v140, v141, s[48:51], s76 offen
    s_branch L_t6
L_t4:
    buffer_load_dword v140, v141, s[52:55], s76 offen
L_t6:
    s_mov_b64 exec, -1
    s_nop 0
    v_cvt_pk_bf16_f32 v80, v48, v48
    v_and_b32 v14, 0xffff0000, v80
    v_sub_f32 v14, v48, v14
    v_cvt_pk_bf16_f32 v81, v14, 0
    v_cvt_pk_bf16_f32 v82, v64, v64
    v_and_b32 v14, 0xffff0000, v82
    v_sub_f32 v14, v64, v14
    v_cvt_pk_bf16_f32 v83, v14, 0
    ds_write_b64 v16, v[80:81]
    ds_write_b64 v16, v[82:83] offset:1024
    s_waitcnt lgkmcnt(0)
    s_setprio 0
    s_barrier
    v_mov_b32 v44, v40
    v_mov_b32 v45, v41
    v_mov_b32 v46, v40
    v_mov_b32 v47, v41
    v_add_u32 v18, 98304, v6
    s_lshl_b32 s76, s6, 10
    v_add_u32 v19, s76, v18
    s_and_b32 s76, s6, 1
    s_lshl_b32 s77, s68, 1
    s_add_u32 s76, s76, s77
    s_lshl_b32 s77, s4, 2
    s_add_u32 s86, s76, s77
    s_mul_i32 s76, s86, 28672
    s_lshr_b32 s77, s6, 1
    s_lshl_b32 s77, s77, 6
    s_lshl_b32 s78, s69, 7
    s_add_u32 s77, s77, s78
    s_add_u32 s72, s76, s77
    v_lshrrev_b32 v21, 4, v1
    v_lshlrev_b32 v21, 3, v21
    s_mov_b32 s60, s24
    s_mov_b32 s61, s25
    s_mov_b32 s62, 896
    s_mov_b32 s63, 0x00020000
    buffer_load_dwordx2 v[104:105], v21, s[60:63], s77 offen offset:0
    buffer_load_dwordx2 v[106:107], v21, s[60:63], s77 offen offset:32
    s_mov_b32 s60, s98
    s_mov_b32 s61, s99
    s_mov_b32 s62, 3584
    s_mov_b32 s63, 0x00020000
    s_lshl_b32 s76, s4, 1
    s_add_u32 s76, s76, s5
    s_sub_u32 s27, s76, 14
    s_lshl_b32 s76, s27, 7
    s_lshl_b32 s77, s5, 8
    s_cmp_ge_u32 s5, 14
    s_cselect_b32 s7, s76, s77
    v_lshlrev_b32 v21, 1, v2
    buffer_load_ushort v100, v21, s[60:63], s7 offen offset:0
    buffer_load_ushort v101, v21, s[60:63], s7 offen offset:64
    v_add_u32 v16, 160768, v23
    v_add_u32 v17, 160768, v5
    s_mul_i32 s88, s6, 100352
    s_lshl_b32 s77, s69, 7
    s_add_u32 s88, s88, s77
    s_mul_i32 s89, s6, 14336
    s_add_u32 s89, s89, 0
    s_lshl_b32 s26, s97, 1
    s_add_u32 s78, s26, 0
    s_add_u32 s80, s26, -7
    s_min_u32 s78, s78, s80
    s_mul_i32 s76, s78, 14336
    s_add_u32 s76, s76, s88
    s_lshl_b32 s77, s78, 11
    s_add_u32 s77, s77, s89
    s_mov_b32 m0, s77
    s_nop 0
    buffer_load_dwordx4 v9, s[44:47], s76 offen offset:0 lds
    s_add_u32 s76, s76, 6144
    buffer_load_dwordx4 v9, s[44:47], s76 offen offset:1024 lds
    s_add_u32 s78, s26, 1
    s_add_u32 s80, s26, -6
    s_min_u32 s78, s78, s80
    s_mul_i32 s76, s78, 14336
    s_add_u32 s76, s76, s88
    s_lshl_b32 s77, s78, 11
    s_add_u32 s77, s77, s89
    s_mov_b32 m0, s77
    s_nop 0
    buffer_load_dwordx4 v9, s[44:47], s76 offen offset:0 lds
    s_add_u32 s76, s76, 6144
    buffer_load_dwordx4 v9, s[44:47], s76 offen offset:1024 lds
    s_add_u32 s78, s26, 2
    s_add_u32 s80, s26, -5
    s_min_u32 s78, s78, s80
    s_mul_i32 s76, s78, 14336
    s_add_u32 s76, s76, s88
    s_lshl_b32 s77, s78, 11
    s_add_u32 s77, s77, s89
    s_mov_b32 m0, s77
    s_nop 0
    buffer_load_dwordx4 v9, s[44:47], s76 offen offset:0 lds
    s_add_u32 s76, s76, 6144
    buffer_load_dwordx4 v9, s[44:47], s76 offen offset:1024 lds
    s_add_u32 s78, s26, 3
    s_add_u32 s80, s26, -4
    s_min_u32 s78, s78, s80
    s_mul_i32 s76, s78, 14336
    s_add_u32 s76, s76, s88
    s_lshl_b32 s77, s78, 11
    s_add_u32 s77, s77, s89
    s_mov_b32 m0, s77
    s_nop 0
    buffer_load_dwordx4 v9, s[44:47], s76 offen offset:0 lds
    s_add_u32 s76, s76, 6144
    buffer_load_dwordx4 v9, s[44:47], s76 offen offset:1024 lds
L_lw_35:
    ds_read_b32 v13, v31 offset:56
    s_add_u32 s75, s75, 1
    s_waitcnt lgkmcnt(0)
    v_readfirstlane_b32 s80, v13
    s_nop 0
    s_cmp_ge_u32 s80, 4
    s_cbranch_scc1 L_lwd_36
    s_cmp_lt_u32 s75, 200000
    s_cbranch_scc1 L_lw_35
L_lwd_36:
    ds_read_b64_tr_b16 v[64:65], v19 offset:0
    ds_read_b64_tr_b16 v[66:67], v19 offset:256
    ds_read_b64_tr_b16 v[68:69], v19 offset:4096
    ds_read_b64_tr_b16 v[70:71], v19 offset:4352
    ds_read_b64_tr_b16 v[72:73], v19 offset:8192
    ds_read_b64_tr_b16 v[74:75], v19 offset:8448
    ds_read_b64_tr_b16 v[76:77], v19 offset:12288
    ds_read_b64_tr_b16 v[78:79], v19 offset:12544
    ds_read_b64_tr_b16 v[80:81], v19 offset:16384
    ds_read_b64_tr_b16 v[82:83], v19 offset:16640
    ds_read_b64_tr_b16 v[84:85], v19 offset:20480
    ds_read_b64_tr_b16 v[86:87], v19 offset:20736
    ds_read_b64_tr_b16 v[88:89], v19 offset:24576
    ds_read_b64_tr_b16 v[90:91], v19 offset:24832
    s_mul_i32 s81, s6, 57344
    s_add_u32 s81, s81, s7
    s_lshl_b32 s82, s6, 11
    ds_read_b64_tr_b16 v[128:129], v30 offset:0
    ds_read_b64_tr_b16 v[130:131], v30 offset:512
    ds_read_b64_tr_b16 v[132:133], v30 offset:1024
    ds_read_b64_tr_b16 v[134:135], v30 offset:1536
    s_waitcnt lgkmcnt(4)
    v_mfma_f32_32x32x16_bf16 v[48:63], v[32:35], v[64:67], 0
    v_mfma_f32_32x32x16_bf16 v[48:63], v[32:35], v[68:71], v[48:63]
    v_mfma_f32_32x32x16_bf16 v[48:63], v[32:35], v[72:75], v[48:63]
    v_mfma_f32_32x32x16_bf16 v[48:63], v[32:35], v[76:79], v[48:63]
    v_mfma_f32_32x32x16_bf16 v[48:63], v[32:35], v[80:83], v[48:63]
    v_mfma_f32_32x32x16_bf16 v[48:63], v[32:35], v[84:87], v[48:63]
    v_mfma_f32_32x32x16_bf16 v[48:63], v[32:35], v[88:91], v[48:63]
    ds_read_b64_tr_b16 v[64:65], v18 offset:0
    ds_read_b64_tr_b16 v[66:67], v18 offset:256
    ds_read_b64_tr_b16 v[68:69], v18 offset:1024
    ds_read_b64_tr_b16 v[70:71], v18 offset:1280
    ds_read_b64_tr_b16 v[72:73], v18 offset:2048
    ds_read_b64_tr_b16 v[74:75], v18 offset:2304
    ds_read_b64_tr_b16 v[76:77], v18 offset:3072
    ds_read_b64_tr_b16 v[78:79], v18 offset:3328
    ds_read_b64_tr_b16 v[80:81], v18 offset:4096
    ds_read_b64_tr_b16 v[82:83], v18 offset:4352
    s_waitcnt lgkmcnt(8)
    v_mfma_f32_32x32x16_bf16 v[112:127], v[64:67], v[144:147], 0
    ds_read_b64_tr_b16 v[84:85], v18 offset:5120
    ds_read_b64_tr_b16 v[86:87], v18 offset:5376
    s_waitcnt lgkmcnt(8)
    v_mfma_f32_32x32x16_bf16 v[112:127], v[68:71], v[148:151], v[112:127]
    s_add_u32 s78, s26, 4
    s_add_u32 s80, s26, -3
    s_min_u32 s78, s78, s80
    s_mul_i32 s76, s78, 14336
    s_add_u32 s76, s76, s88
    s_lshl_b32 s77, s78, 11
    s_add_u32 s77, s77, s89
    s_mov_b32 m0, s77
    s_nop 0
    buffer_load_dwordx4 v9, s[44:47], s76 offen offset:0 lds
    s_add_u32 s76, s76, 6144
    buffer_load_dwordx4 v9, s[44:47], s76 offen offset:1024 lds
    ds_read_b64_tr_b16 v[88:89], v18 offset:6144
    ds_read_b64_tr_b16 v[90:91], v18 offset:6400
    s_waitcnt lgkmcnt(8)
    v_mfma_f32_32x32x16_bf16 v[112:127], v[72:75], v[152:155], v[112:127]
    ds_read_b64_tr_b16 v[92:93], v18 offset:7168
    ds_read_b64_tr_b16 v[94:95], v18 offset:7424
    s_waitcnt lgkmcnt(8)
    v_mfma_f32_32x32x16_bf16 v[112:127], v[76:79], v[156:159], v[112:127]
    v_cvt_pk_bf16_f32 v96, v48, v48
    v_and_b32 v14, 0xffff0000, v96
    v_sub_f32 v14, v48, v14
    v_cvt_pk_bf16_f32 v97, v14, 0
    ds_write_b64 v16, v[96:97]
    ds_read_b64_tr_b16 v[64:65], v18 offset:8192
    ds_read_b64_tr_b16 v[66:67], v18 offset:8448
    s_waitcnt lgkmcnt(9)
    v_mfma_f32_32x32x16_bf16 v[112:127], v[80:83], v[160:163], v[112:127]
    ds_read_b64_tr_b16 v[68:69], v18 offset:9216
    ds_read_b64_tr_b16 v[70:71], v18 offset:9472
    s_waitcnt lgkmcnt(9)
    v_mfma_f32_32x32x16_bf16 v[112:127], v[84:87], v[164:167], v[112:127]
    s_add_u32 s78, s26, 5
    s_add_u32 s80, s26, -2
    s_min_u32 s78, s78, s80
    s_mul_i32 s76, s78, 14336
    s_add_u32 s76, s76, s88
    s_lshl_b32 s77, s78, 11
    s_add_u32 s77, s77, s89
    s_mov_b32 m0, s77
    s_nop 0
    buffer_load_dwordx4 v9, s[44:47], s76 offen offset:0 lds
    s_add_u32 s76, s76, 6144
    buffer_load_dwordx4 v9, s[44:47], s76 offen offset:1024 lds
    ds_read_b64_tr_b16 v[72:73], v18 offset:10240
    ds_read_b64_tr_b16 v[74:75], v18 offset:10496
    s_waitcnt lgkmcnt(9)
    v_mfma_f32_32x32x16_bf16 v[112:127], v[88:91], v[168:171], v[112:127]
    ds_read_b64_tr_b16 v[76:77], v18 offset:11264
    ds_read_b64_tr_b16 v[78:79], v18 offset:11520
    s_waitcnt lgkmcnt(9)
    v_mfma_f32_32x32x16_bf16 v[112:127], v[92:95], v[172:175], v[112:127]
    ds_read_b64_tr_b16 v[80:81], v18 offset:12288
    ds_read_b64_tr_b16 v[82:83], v18 offset:12544
    s_waitcnt lgkmcnt(8)
    v_mfma_f32_32x32x16_bf16 v[112:127], v[64:67], v[176:179], v[112:127]
    ds_read_b64_tr_b16 v[84:85], v18 offset:13312
    ds_read_b64_tr_b16 v[86:87], v18 offset:13568
    s_waitcnt lgkmcnt(8)
    v_mfma_f32_32x32x16_bf16 v[112:127], v[68:71], v[180:183], v[112:127]
    s_add_u32 s78, s26, 6
    s_add_u32 s80, s26, -1
    s_min_u32 s78, s78, s80
    s_mul_i32 s76, s78, 14336
    s_add_u32 s76, s76, s88
    s_lshl_b32 s77, s78, 11
    s_add_u32 s77, s77, s89
    s_mov_b32 m0, s77
    s_nop 0
    buffer_load_dwordx4 v9, s[44:47], s76 offen offset:0 lds
    s_add_u32 s76, s76, 6144
    buffer_load_dwordx4 v9, s[44:47], s76 offen offset:1024 lds
    ds_read_b64_tr_b16 v[88:89], v18 offset:14336
    ds_read_b64_tr_b16 v[90:91], v18 offset:14592
    s_waitcnt lgkmcnt(8)
    v_mfma_f32_32x32x16_bf16 v[112:127], v[72:75], v[184:187], v[112:127]
    ds_read_b64_tr_b16 v[92:93], v18 offset:15360
    ds_read_b64_tr_b16 v[94:95], v18 offset:15616
    s_waitcnt lgkmcnt(8)
    v_mfma_f32_32x32x16_bf16 v[112:127], v[76:79], v[188:191], v[112:127]
    ds_read_b64_tr_b16 v[64:65], v18 offset:16384
    ds_read_b64_tr_b16 v[66:67], v18 offset:16640
    s_waitcnt lgkmcnt(8)
    v_mfma_f32_32x32x16_bf16 v[112:127], v[80:83], v[192:195], v[112:127]
    ds_read_b64_tr_b16 v[68:69], v18 offset:17408
    ds_read_b64_tr_b16 v[70:71], v18 offset:17664
    s_waitcnt lgkmcnt(8)
    v_mfma_f32_32x32x16_bf16 v[112:127], v[84:87], v[196:199], v[112:127]
    ds_read_b64_tr_b16 v[72:73], v18 offset:18432
    ds_read_b64_tr_b16 v[74:75], v18 offset:18688
    s_waitcnt lgkmcnt(8)
    v_mfma_f32_32x32x16_bf16 v[112:127], v[88:91], v[200:203], v[112:127]
    ds_read_b64_tr_b16 v[76:77], v18 offset:19456
    ds_read_b64_tr_b16 v[78:79], v18 offset:19712
    s_waitcnt lgkmcnt(8)
    v_mfma_f32_32x32x16_bf16 v[112:127], v[92:95], v[204:207], v[112:127]
    ds_read_b64_tr_b16 v[80:81], v18 offset:20480
    ds_read_b64_tr_b16 v[82:83], v18 offset:20736
    s_waitcnt lgkmcnt(8)
    v_mfma_f32_32x32x16_bf16 v[112:127], v[64:67], v[208:211], v[112:127]
    ds_read_b64_tr_b16 v[84:85], v18 offset:21504
    ds_read_b64_tr_b16 v[86:87], v18 offset:21760
    s_waitcnt lgkmcnt(8)
    v_mfma_f32_32x32x16_bf16 v[112:127], v[68:71], v[212:215], v[112:127]
    ds_read_b64_tr_b16 v[88:89], v18 offset:22528
    ds_read_b64_tr_b16 v[90:91], v18 offset:22784
    s_waitcnt lgkmcnt(8)
    v_mfma_f32_32x32x16_bf16 v[112:127], v[72:75], v[216:219], v[112:127]
    ds_read_b64_tr_b16 v[92:93], v18 offset:23552
    ds_read_b64_tr_b16 v[94:95], v18 offset:23808
    s_waitcnt lgkmcnt(8)
    v_mfma_f32_32x32x16_bf16 v[112:127], v[76:79], v[220:223], v[112:127]
    ds_read_b64_tr_b16 v[64:65], v18 offset:24576
    ds_read_b64_tr_b16 v[66:67], v18 offset:24832
    s_waitcnt lgkmcnt(8)
    v_mfma_f32_32x32x16_bf16 v[112:127], v[80:83], v[224:227], v[112:127]
    ds_read_b64_tr_b16 v[68:69], v18 offset:25600
    ds_read_b64_tr_b16 v[70:71], v18 offset:25856
    s_waitcnt lgkmcnt(8)
    v_mfma_f32_32x32x16_bf16 v[112:127], v[84:87], v[228:231], v[112:127]
    ds_read_b64_tr_b16 v[72:73], v18 offset:26624
    ds_read_b64_tr_b16 v[74:75], v18 offset:26880
    s_waitcnt lgkmcnt(8)
    v_mfma_f32_32x32x16_bf16 v[112:127], v[88:91], v[232:235], v[112:127]
    ds_read_b64_tr_b16 v[76:77], v18 offset:27648
    ds_read_b64_tr_b16 v[78:79], v18 offset:27904
    s_waitcnt lgkmcnt(8)
    v_mfma_f32_32x32x16_bf16 v[112:127], v[92:95], v[236:239], v[112:127]
    s_waitcnt lgkmcnt(6)
    v_mfma_f32_32x32x16_bf16 v[112:127], v[64:67], v[240:243], v[112:127]
    s_waitcnt lgkmcnt(4)
    v_mfma_f32_32x32x16_bf16 v[112:127], v[68:71], v[244:247], v[112:127]
    s_waitcnt lgkmcnt(2)
    v_mfma_f32_32x32x16_bf16 v[112:127], v[72:75], v[248:251], v[112:127]
    s_waitcnt lgkmcnt(0)
    v_mfma_f32_32x32x16_bf16 v[112:127], v[76:79], v[252:255], v[112:127]
    s_mov_b64 exec, 1
    ds_add_u32 v31, v11 offset:4
    s_mov_b64 exec, -1
L_lw_37:
    ds_read_b32 v13, v31 offset:4
    s_add_u32 s75, s75, 1
    s_waitcnt lgkmcnt(0)
    v_readfirstlane_b32 s80, v13
    s_nop 0
    s_cmp_ge_u32 s80, 8
    s_cbranch_scc1 L_lwd_38
    s_cmp_lt_u32 s75, 200000
    s_cbranch_scc1 L_lw_37
L_lwd_38:
    ds_read_b128 v[136:139], v17
    s_waitcnt lgkmcnt(0)
    v_mfma_f32_32x32x16_bf16 v[112:127], v[136:139], v[44:47], v[112:127]
    s_nop 11
    v_cvt_pk_bf16_f32 v68, v112, v113
    v_cvt_pk_bf16_f32 v69, v114, v115
    v_cvt_pk_bf16_f32 v70, v116, v117
    v_cvt_pk_bf16_f32 v71, v118, v119
    v_cvt_pk_bf16_f32 v72, v120, v121
    v_cvt_pk_bf16_f32 v73, v122, v123
    v_cvt_pk_bf16_f32 v74, v124, v125
    v_cvt_pk_bf16_f32 v75, v126, v127
    v_mfma_f32_32x32x16_bf16 v[48:63], v[128:131], v[68:71], 0
    s_nop 0
    v_mfma_f32_32x32x16_bf16 v[48:63], v[132:135], v[72:75], v[48:63]
    s_add_u32 s76, s29, 0
    s_add_u32 s80, s29, -7
    s_min_u32 s76, s76, s80
    s_mul_i32 s76, s76, 229376
    s_add_u32 s76, s76, s81
    s_add_u32 s76, s76, 0
    s_add_u32 s77, s82, 57344
    s_mov_b32 m0, s77
    s_nop 0
    buffer_load_dwordx4 v10, s[48:51], s76 offen offset:0 lds
    s_add_u32 s76, s76, 27648
    buffer_load_dwordx4 v10, s[48:51], s76 offen offset:1024 lds
    s_add_u32 s76, s29, 1
    s_add_u32 s80, s29, -6
    s_min_u32 s76, s76, s80
    s_mul_i32 s76, s76, 229376
    s_add_u32 s76, s76, s81
    s_add_u32 s76, s76, 0
    s_add_u32 s77, s82, 65536
    s_mov_b32 m0, s77
    s_nop 0
    buffer_load_dwordx4 v10, s[48:51], s76 offen offset:0 lds
    s_add_u32 s76, s76, 27648
    buffer_load_dwordx4 v10, s[48:51], s76 offen offset:1024 lds
    v_max3_f32 v80, v48, v49, v50
    v_min3_f32 v81, v48, v49, v50
    v_max3_f32 v80, v51, v52, v80
    v_min3_f32 v81, v51, v52, v81
    v_max3_f32 v80, v53, v54, v80
    v_min3_f32 v81, v53, v54, v81
    v_max3_f32 v80, v55, v56, v80
    v_min3_f32 v81, v55, v56, v81
    v_max3_f32 v80, v57, v58, v80
    v_min3_f32 v81, v57, v58, v81
    v_max3_f32 v80, v59, v60, v80
    v_min3_f32 v81, v59, v60, v81
    v_max3_f32 v80, v61, v62, v80
    v_min3_f32 v81, v61, v62, v81
    v_max_f32 v80, v63, v80
    v_min_f32 v81, v63, v81
    v_mov_b32 v82, v80
    v_mov_b32 v83, v81
    v_mul_f32 v88, s84, v42
    v_permlane32_swap_b32 v80, v82
    v_permlane32_swap_b32 v81, v83
    v_max_f32 v80, v80, v82
    v_min_f32 v81, v81, v83
    v_mul_f32 v80, v80, v88
    v_mul_f32 v81, v81, v88
    v_pk_fma_f32 v[64:65], v[48:49], v[88:89], v[80:81] op_sel:[0,0,1] op_sel_hi:[1,0,1] neg_lo:[1,0,0] neg_hi:[1,0,0]
    v_pk_fma_f32 v[48:49], v[48:49], v[88:89], v[80:81] op_sel:[0,0,0] op_sel_hi:[1,0,0] neg_lo:[0,0,1] neg_hi:[0,0,1]
    v_pk_fma_f32 v[66:67], v[50:51], v[88:89], v[80:81] op_sel:[0,0,1] op_sel_hi:[1,0,1] neg_lo:[1,0,0] neg_hi:[1,0,0]
    v_pk_fma_f32 v[50:51], v[50:51], v[88:89], v[80:81] op_sel:[0,0,0] op_sel_hi:[1,0,0] neg_lo:[0,0,1] neg_hi:[0,0,1]
    v_pk_fma_f32 v[68:69], v[52:53], v[88:89], v[80:81] op_sel:[0,0,1] op_sel_hi:[1,0,1] neg_lo:[1,0,0] neg_hi:[1,0,0]
    v_pk_fma_f32 v[52:53], v[52:53], v[88:89], v[80:81] op_sel:[0,0,0] op_sel_hi:[1,0,0] neg_lo:[0,0,1] neg_hi:[0,0,1]
    v_pk_fma_f32 v[70:71], v[54:55], v[88:89], v[80:81] op_sel:[0,0,1] op_sel_hi:[1,0,1] neg_lo:[1,0,0] neg_hi:[1,0,0]
    v_pk_fma_f32 v[54:55], v[54:55], v[88:89], v[80:81] op_sel:[0,0,0] op_sel_hi:[1,0,0] neg_lo:[0,0,1] neg_hi:[0,0,1]
    v_pk_fma_f32 v[72:73], v[56:57], v[88:89], v[80:81] op_sel:[0,0,1] op_sel_hi:[1,0,1] neg_lo:[1,0,0] neg_hi:[1,0,0]
    v_pk_fma_f32 v[56:57], v[56:57], v[88:89], v[80:81] op_sel:[0,0,0] op_sel_hi:[1,0,0] neg_lo:[0,0,1] neg_hi:[0,0,1]
    v_pk_fma_f32 v[74:75], v[58:59], v[88:89], v[80:81] op_sel:[0,0,1] op_sel_hi:[1,0,1] neg_lo:[1,0,0] neg_hi:[1,0,0]
    v_pk_fma_f32 v[58:59], v[58:59], v[88:89], v[80:81] op_sel:[0,0,0] op_sel_hi:[1,0,0] neg_lo:[0,0,1] neg_hi:[0,0,1]
    v_pk_fma_f32 v[76:77], v[60:61], v[88:89], v[80:81] op_sel:[0,0,1] op_sel_hi:[1,0,1] neg_lo:[1,0,0] neg_hi:[1,0,0]
    v_pk_fma_f32 v[60:61], v[60:61], v[88:89], v[80:81] op_sel:[0,0,0] op_sel_hi:[1,0,0] neg_lo:[0,0,1] neg_hi:[0,0,1]
    v_pk_fma_f32 v[78:79], v[62:63], v[88:89], v[80:81] op_sel:[0,0,1] op_sel_hi:[1,0,1] neg_lo:[1,0,0] neg_hi:[1,0,0]
    v_pk_fma_f32 v[62:63], v[62:63], v[88:89], v[80:81] op_sel:[0,0,0] op_sel_hi:[1,0,0] neg_lo:[0,0,1] neg_hi:[0,0,1]
    v_exp_f32 v48, v48
    v_exp_f32 v64, v64
    v_exp_f32 v49, v49
    v_exp_f32 v65, v65
    v_exp_f32 v50, v50
    v_exp_f32 v66, v66
    v_exp_f32 v51, v51
    v_exp_f32 v67, v67
    v_exp_f32 v52, v52
    v_exp_f32 v68, v68
    v_exp_f32 v53, v53
    v_exp_f32 v69, v69
    v_exp_f32 v54, v54
    v_exp_f32 v70, v70
    v_exp_f32 v55, v55
    v_exp_f32 v71, v71
    v_exp_f32 v56, v56
    v_exp_f32 v72, v72
    v_exp_f32 v57, v57
    v_exp_f32 v73, v73
    v_exp_f32 v58, v58
    v_exp_f32 v74, v74
    v_exp_f32 v59, v59
    v_exp_f32 v75, v75
    v_exp_f32 v60, v60
    v_exp_f32 v76, v76
    v_exp_f32 v61, v61
    v_exp_f32 v77, v77
    v_exp_f32 v62, v62
    v_exp_f32 v78, v78
    v_exp_f32 v63, v63
    v_exp_f32 v79, v79
    v_pk_add_f32 v[82:83], v[60:61], v[62:63]
    v_pk_add_f32 v[86:87], v[76:77], v[78:79]
    v_pk_fma_f32 v[82:83], v[82:83], v[4:5], v[48:49] op_sel:[0,0,0] op_sel_hi:[1,0,1]
    v_pk_fma_f32 v[86:87], v[86:87], v[4:5], v[64:65] op_sel:[0,0,0] op_sel_hi:[1,0,1]
    v_pk_add_f32 v[82:83], v[82:83], v[50:51]
    v_pk_add_f32 v[86:87], v[86:87], v[66:67]
    v_pk_add_f32 v[82:83], v[82:83], v[52:53]
    v_pk_add_f32 v[86:87], v[86:87], v[68:69]
    v_pk_add_f32 v[82:83], v[82:83], v[54:55]
    v_pk_add_f32 v[86:87], v[86:87], v[70:71]
    v_pk_add_f32 v[82:83], v[82:83], v[56:57]
    v_pk_add_f32 v[86:87], v[86:87], v[72:73]
    v_pk_add_f32 v[82:83], v[82:83], v[58:59]
    v_pk_add_f32 v[86:87], v[86:87], v[74:75]
    v_add_f32 v84, v82, v83
    v_add_f32 v85, v86, v87
    v_mov_b32 v82, v84
    v_mov_b32 v83, v85
    s_nop 0
    v_permlane32_swap_b32 v84, v82
    v_permlane32_swap_b32 v85, v83
    v_add_f32 v84, v84, v82
    v_add_f32 v85, v85, v83
    v_rcp_f32 v86, v84
    v_rcp_f32 v87, v85
    v_mul_f32 v82, v86, v4
    v_mul_f32 v83, v87, v4
    v_pk_mul_f32 v[48:49], v[48:49], v[86:87] op_sel:[0,0] op_sel_hi:[1,0]
    v_pk_mul_f32 v[64:65], v[64:65], v[86:87] op_sel:[0,1] op_sel_hi:[1,1]
    v_pk_mul_f32 v[50:51], v[50:51], v[86:87] op_sel:[0,0] op_sel_hi:[1,0]
    v_pk_mul_f32 v[66:67], v[66:67], v[86:87] op_sel:[0,1] op_sel_hi:[1,1]
    v_pk_mul_f32 v[52:53], v[52:53], v[86:87] op_sel:[0,0] op_sel_hi:[1,0]
    v_pk_mul_f32 v[68:69], v[68:69], v[86:87] op_sel:[0,1] op_sel_hi:[1,1]
    v_pk_mul_f32 v[54:55], v[54:55], v[86:87] op_sel:[0,0] op_sel_hi:[1,0]
    v_pk_mul_f32 v[70:71], v[70:71], v[86:87] op_sel:[0,1] op_sel_hi:[1,1]
    v_pk_mul_f32 v[56:57], v[56:57], v[86:87] op_sel:[0,0] op_sel_hi:[1,0]
    v_pk_mul_f32 v[72:73], v[72:73], v[86:87] op_sel:[0,1] op_sel_hi:[1,1]
    v_pk_mul_f32 v[58:59], v[58:59], v[86:87] op_sel:[0,0] op_sel_hi:[1,0]
    v_pk_mul_f32 v[74:75], v[74:75], v[86:87] op_sel:[0,1] op_sel_hi:[1,1]
    v_pk_mul_f32 v[60:61], v[60:61], v[82:83] op_sel:[0,0] op_sel_hi:[1,0]
    v_pk_mul_f32 v[76:77], v[76:77], v[82:83] op_sel:[0,1] op_sel_hi:[1,1]
    v_pk_mul_f32 v[62:63], v[62:63], v[82:83] op_sel:[0,0] op_sel_hi:[1,0]
    v_pk_mul_f32 v[78:79], v[78:79], v[82:83] op_sel:[0,1] op_sel_hi:[1,1]
    v_cvt_pk_bf16_f32 v112, v48, v49
    v_cvt_pk_bf16_f32 v113, v50, v51
    v_cvt_pk_bf16_f32 v114, v52, v53
    v_cvt_pk_bf16_f32 v115, v54, v55
    v_cvt_pk_bf16_f32 v116, v56, v57
    v_cvt_pk_bf16_f32 v117, v58, v59
    v_cvt_pk_bf16_f32 v118, v60, v61
    v_cvt_pk_bf16_f32 v119, v62, v63
    v_cvt_pk_bf16_f32 v120, v64, v65
    v_cvt_pk_bf16_f32 v121, v66, v67
    v_cvt_pk_bf16_f32 v122, v68, v69
    v_cvt_pk_bf16_f32 v123, v70, v71
    v_cvt_pk_bf16_f32 v124, v72, v73
    v_cvt_pk_bf16_f32 v125, v74, v75
    v_cvt_pk_bf16_f32 v126, v76, v77
    v_cvt_pk_bf16_f32 v127, v78, v79
    s_add_u32 s76, s29, 2
    s_add_u32 s80, s29, -5
    s_min_u32 s76, s76, s80
    s_mul_i32 s76, s76, 229376
    s_add_u32 s76, s76, s81
    s_add_u32 s76, s76, 0
    s_add_u32 s77, s82, 73728
    s_mov_b32 m0, s77
    s_nop 0
    buffer_load_dwordx4 v10, s[48:51], s76 offen offset:0 lds
    s_add_u32 s76, s76, 27648
    buffer_load_dwordx4 v10, s[48:51], s76 offen offset:1024 lds
    s_add_u32 s76, s29, 3
    s_add_u32 s80, s29, -4
    s_min_u32 s76, s76, s80
    s_mul_i32 s76, s76, 229376
    s_add_u32 s76, s76, s81
    s_add_u32 s76, s76, 0
    s_add_u32 s77, s82, 81920
    s_mov_b32 m0, s77
    s_nop 0
    buffer_load_dwordx4 v10, s[48:51], s76 offen offset:0 lds
    s_add_u32 s76, s76, 27648
    buffer_load_dwordx4 v10, s[48:51], s76 offen offset:1024 lds
    s_add_u32 s76, s29, 4
    s_add_u32 s80, s29, -3
    s_min_u32 s76, s76, s80
    s_mul_i32 s76, s76, 229376
    s_add_u32 s76, s76, s81
    s_add_u32 s76, s76, 0
    s_add_u32 s77, s82, 90112
    s_mov_b32 m0, s77
    s_nop 0
    buffer_load_dwordx4 v10, s[48:51], s76 offen offset:0 lds
    s_add_u32 s76, s76, 27648
    buffer_load_dwordx4 v10, s[48:51], s76 offen offset:1024 lds
    s_add_u32 s76, s29, 5
    s_add_u32 s80, s29, -2
    s_min_u32 s76, s76, s80
    s_mul_i32 s76, s76, 229376
    s_add_u32 s76, s76, s81
    s_add_u32 s76, s76, 0
    s_add_u32 s77, s82, 98304
    s_mov_b32 m0, s77
    s_nop 0
    buffer_load_dwordx4 v10, s[48:51], s76 offen offset:0 lds
    s_add_u32 s76, s76, 27648
    buffer_load_dwordx4 v10, s[48:51], s76 offen offset:1024 lds
    s_add_u32 s76, s29, 6
    s_add_u32 s80, s29, -1
    s_min_u32 s76, s76, s80
    s_mul_i32 s76, s76, 229376
    s_add_u32 s76, s76, s81
    s_add_u32 s76, s76, 0
    s_add_u32 s77, s82, 106496
    s_mov_b32 m0, s77
    s_nop 0
    buffer_load_dwordx4 v10, s[48:51], s76 offen offset:0 lds
    s_add_u32 s76, s76, 27648
    buffer_load_dwordx4 v10, s[48:51], s76 offen offset:1024 lds
    s_add_u32 s76, s29, 0
    s_add_u32 s80, s29, -7
    s_min_u32 s76, s76, s80
    s_mul_i32 s76, s76, 229376
    s_add_u32 s76, s76, s81
    s_add_u32 s76, s76, 128
    s_add_u32 s77, s82, 114688
    s_mov_b32 m0, s77
    s_nop 0
    buffer_load_dwordx4 v10, s[48:51], s76 offen offset:0 lds
    s_add_u32 s76, s76, 27648
    buffer_load_dwordx4 v10, s[48:51], s76 offen offset:1024 lds
    s_add_u32 s76, s29, 1
    s_add_u32 s80, s29, -6
    s_min_u32 s76, s76, s80
    s_mul_i32 s76, s76, 229376
    s_add_u32 s76, s76, s81
    s_add_u32 s76, s76, 128
    s_add_u32 s77, s82, 122880
    s_mov_b32 m0, s77
    s_nop 0
    buffer_load_dwordx4 v10, s[48:51], s76 offen offset:0 lds
    s_add_u32 s76, s76, 27648
    buffer_load_dwordx4 v10, s[48:51], s76 offen offset:1024 lds
    v_add_u32 v17, 154624, v5
    s_lshl_b32 s77, s68, 3
    s_add_u32 s77, s77, s69
    s_lshl_b32 s76, s4, 2
    s_add_u32 s76, s76, s6
    s_lshl_b32 s88, s76, 15
    s_lshl_b32 s78, s77, 11
    s_add_u32 s88, s88, s78
    s_add_u32 s88, s88, 2097152
    s_lshl_b32 s76, s76, 2
    s_lshr_b32 s77, s77, 2
    s_add_u32 s76, s76, s77
    s_lshl_b32 s76, s76, 7
    s_add_u32 s85, s76, 32768
    v_add_u32 v20, s82, v7
    v_add_u32 v21, s82, v8
    v_add_u32 v18, 57344, v20
    v_add_u32 v19, 57344, v21
    v_add_u32 v26, 114688, v20
    v_add_u32 v27, 114688, v21
    s_waitcnt vmcnt(18)
    s_setprio 3
    s_barrier
    ds_read_b128 v[64:67], v17 offset:0
    ds_read_b128 v[68:71], v17 offset:1024
    ds_read_b128 v[72:75], v17 offset:2048
    ds_read_b128 v[76:79], v17 offset:3072
    s_waitcnt lgkmcnt(3)
    v_mfma_f32_32x32x16_bf16 v[48:63], v[64:67], v[112:115], 0
    s_waitcnt lgkmcnt(2)
    v_mfma_f32_32x32x16_bf16 v[48:63], v[68:71], v[116:119], v[48:63]
    s_waitcnt lgkmcnt(1)
    v_mfma_f32_32x32x16_bf16 v[48:63], v[72:75], v[120:123], v[48:63]
    s_waitcnt lgkmcnt(0)
    v_mfma_f32_32x32x16_bf16 v[48:63], v[76:79], v[124:127], v[48:63]
    s_nop 11
    v_mov_b32 v14, v60
    v_mov_b32 v15, v60
    s_nop 1
    v_permlane32_swap_b32 v14, v15
    v_add_f32 v15, 0x358637bd, v15
    v_rcp_f32 v14, v15
    s_nop 0
    v_mul_f32 v15, v14, v4
    v_pk_mul_f32 v[48:49], v[48:49], v[14:15] op_sel:[0,0] op_sel_hi:[1,0]
    v_pk_mul_f32 v[50:51], v[50:51], v[14:15] op_sel:[0,0] op_sel_hi:[1,0]
    v_pk_mul_f32 v[52:53], v[52:53], v[14:15] op_sel:[0,0] op_sel_hi:[1,0]
    v_pk_mul_f32 v[54:55], v[54:55], v[14:15] op_sel:[0,0] op_sel_hi:[1,0]
    v_pk_mul_f32 v[56:57], v[56:57], v[14:15] op_sel:[0,0] op_sel_hi:[1,0]
    v_pk_mul_f32 v[58:59], v[58:59], v[14:15] op_sel:[0,0] op_sel_hi:[1,0]
    v_pk_mul_f32 v[60:61], v[60:61], v[14:15] op_sel:[0,1] op_sel_hi:[1,1]
    v_pk_mul_f32 v[62:63], v[62:63], v[14:15] op_sel:[0,1] op_sel_hi:[1,1]
    v_cvt_pk_bf16_f32 v64, v48, v49
    v_cvt_pk_bf16_f32 v65, v50, v51
    v_cvt_pk_bf16_f32 v66, v52, v53
    v_cvt_pk_bf16_f32 v67, v54, v55
    v_cvt_pk_bf16_f32 v68, v56, v57
    v_cvt_pk_bf16_f32 v69, v58, v59
    v_cvt_pk_bf16_f32 v70, v60, v61
    v_cvt_pk_bf16_f32 v71, v62, v63
    buffer_store_dwordx4 v[64:67], v5, s[40:43], s88 offen sc1
    buffer_store_dwordx4 v[68:71], v5, s[40:43], s88 offen offset:1024 sc1
    v_lshlrev_b32 v0, 7, v1
    s_waitcnt vmcnt(0)
    s_mov_b64 exec, 1
    buffer_atomic_add v11, off, s[40:43], s85
    s_mov_b64 exec, -1
    s_setprio 0
    s_cmp_ge_u32 s5, 14
    s_cbranch_scc0 L_hwork
    s_cmp_ge_u32 s27, 28
    s_cbranch_scc1 L_idle
    ds_read_b64_tr_b16 v[128:129], v18 offset:0
    ds_read_b64_tr_b16 v[130:131], v18 offset:1024
    ds_read_b64_tr_b16 v[132:133], v19 offset:0
    ds_read_b64_tr_b16 v[134:135], v19 offset:1024
    ds_read_b64_tr_b16 v[136:137], v18 offset:8192
    ds_read_b64_tr_b16 v[138:139], v18 offset:9216
    ds_read_b64_tr_b16 v[140:141], v19 offset:8192
    ds_read_b64_tr_b16 v[142:143], v19 offset:9216
    ds_read_b64_tr_b16 v[144:145], v18 offset:16384
    ds_read_b64_tr_b16 v[146:147], v18 offset:17408
    ds_read_b64_tr_b16 v[148:149], v19 offset:16384
    ds_read_b64_tr_b16 v[150:151], v19 offset:17408
    ds_read_b64_tr_b16 v[152:153], v18 offset:24576
    ds_read_b64_tr_b16 v[154:155], v18 offset:25600
    ds_read_b64_tr_b16 v[156:157], v19 offset:24576
    ds_read_b64_tr_b16 v[158:159], v19 offset:25600
    s_waitcnt lgkmcnt(14)
    v_mfma_f32_32x32x16_bf16 v[48:63], v[32:35], v[128:131], 0
    s_waitcnt lgkmcnt(12)
    v_mfma_f32_32x32x16_bf16 v[64:79], v[32:35], v[132:135], 0
    s_waitcnt lgkmcnt(10)
    v_mfma_f32_32x32x16_bf16 v[48:63], v[32:35], v[136:139], v[48:63]
    s_waitcnt lgkmcnt(8)
    v_mfma_f32_32x32x16_bf16 v[64:79], v[32:35], v[140:143], v[64:79]
    s_waitcnt lgkmcnt(6)
    v_mfma_f32_32x32x16_bf16 v[48:63], v[32:35], v[144:147], v[48:63]
    s_waitcnt lgkmcnt(4)
    v_mfma_f32_32x32x16_bf16 v[64:79], v[32:35], v[148:151], v[64:79]
    s_waitcnt lgkmcnt(2)
    v_mfma_f32_32x32x16_bf16 v[48:63], v[32:35], v[152:155], v[48:63]
    s_waitcnt lgkmcnt(0)
    v_mfma_f32_32x32x16_bf16 v[64:79], v[32:35], v[156:159], v[64:79]
    ds_read_b64_tr_b16 v[128:129], v18 offset:32768
    ds_read_b64_tr_b16 v[130:131], v18 offset:33792
    ds_read_b64_tr_b16 v[132:133], v19 offset:32768
    ds_read_b64_tr_b16 v[134:135], v19 offset:33792
    ds_read_b64_tr_b16 v[136:137], v18 offset:40960
    ds_read_b64_tr_b16 v[138:139], v18 offset:41984
    ds_read_b64_tr_b16 v[140:141], v19 offset:40960
    ds_read_b64_tr_b16 v[142:143], v19 offset:41984
    ds_read_b64_tr_b16 v[144:145], v18 offset:49152
    ds_read_b64_tr_b16 v[146:147], v18 offset:50176
    ds_read_b64_tr_b16 v[148:149], v19 offset:49152
    ds_read_b64_tr_b16 v[150:151], v19 offset:50176
    s_waitcnt lgkmcnt(10)
    v_mfma_f32_32x32x16_bf16 v[48:63], v[32:35], v[128:131], v[48:63]
    s_waitcnt lgkmcnt(8)
    v_mfma_f32_32x32x16_bf16 v[64:79], v[32:35], v[132:135], v[64:79]
    s_waitcnt lgkmcnt(6)
    v_mfma_f32_32x32x16_bf16 v[48:63], v[32:35], v[136:139], v[48:63]
    s_waitcnt lgkmcnt(4)
    v_mfma_f32_32x32x16_bf16 v[64:79], v[32:35], v[140:143], v[64:79]
    s_waitcnt lgkmcnt(2)
    v_mfma_f32_32x32x16_bf16 v[48:63], v[32:35], v[144:147], v[48:63]
    s_waitcnt lgkmcnt(0)
    v_mfma_f32_32x32x16_bf16 v[64:79], v[32:35], v[148:151], v[64:79]
    s_cmp_lt_u32 s6, 2
    s_cselect_b32 s76, 0xffff, 0
    s_lshl_b32 s77, s27, 11
    s_add_u32 s77, s77, 1572864
    v_and_b32 v15, s76, v100
    v_lshlrev_b32 v15, 16, v15
    s_nop 3
    v_cvt_pk_bf16_f32 v128, v48, v48
    v_and_b32 v14, 0xffff0000, v128
    v_sub_f32 v14, v48, v14
    v_cvt_pk_bf16_f32 v129, v14, v15
    s_mov_b32 exec_hi, 0
    buffer_store_dwordx2 v[128:129], v23, s[40:43], s77 offen offset:0 sc1
    s_mov_b64 exec, -1
    v_and_b32 v15, s76, v101
    v_lshlrev_b32 v15, 16, v15
    v_cvt_pk_bf16_f32 v130, v64, v64
    v_and_b32 v14, 0xffff0000, v130
    v_sub_f32 v14, v64, v14
    v_cvt_pk_bf16_f32 v131, v14, v15
    s_mov_b32 exec_hi, 0
    buffer_store_dwordx2 v[130:131], v23, s[40:43], s77 offen offset:1024 sc1
    s_mov_b64 exec, -1
    s_lshr_b32 s76, s27, 1
    s_lshl_b32 s76, s76, 9
    s_add_u32 s76, s76, 65920
    s_waitcnt vmcnt(0)
    s_mov_b32 s3, 1
    s_atomic_add s3, s[30:31], s76
    s_branch L_idle
L_hwork:
    s_lshl_b32 s24, s6, 12
    s_add_u32 s24, s24, 24576
    s_lshl_b32 s25, s69, 7
    v_bfe_u32 v14, v1, 2, 3
    v_lshl_add_u32 v14, v3, 4, v14
    v_lshlrev_b32 v14, 7, v14
    v_and_b32 v15, 3, v1
    v_lshl_add_u32 v14, v15, 3, v14
    v_bfe_u32 v15, v1, 3, 1
    v_lshl_add_u32 v14, v15, 6, v14
    s_lshr_b32 s76, s6, 1
    s_lshl_b32 s76, s76, 6
    v_xor_b32 v24, s76, v14
    v_xor_b32 v25, 64, v24
    v_add_u32 v24, s24, v24
    v_add_u32 v25, s24, v25
    v_bfe_u32 v14, v1, 4, 1
    v_and_b32 v15, 15, v1
    v_lshl_add_u32 v14, v14, 5, v15
    v_lshlrev_b32 v14, 4, v14
    v_lshl_add_u32 v30, v3, 10, v14
    v_lshl_add_u32 v6, v3, 3, v14
    v_add_u32 v28, 65536, v24
    v_add_u32 v29, 65536, v25
L_lw_39:
    ds_read_b32 v13, v31 offset:72
    s_add_u32 s75, s75, 1
    s_waitcnt lgkmcnt(0)
    v_readfirstlane_b32 s80, v13
    s_nop 0
    s_cmp_ge_u32 s80, 4
    s_cbranch_scc1 L_lwd_40
    s_cmp_lt_u32 s75, 200000
    s_cbranch_scc1 L_lw_39
L_lwd_40:
    s_mul_i32 s76, s8, 14
    s_add_u32 s76, s76, s25
    s_add_u32 s77, s24, 0
    s_mov_b32 m0, s77
    s_nop 0
    buffer_load_dwordx4 v9, s[52:55], s76 offen offset:0 lds
    s_add_u32 s76, s76, 6144
    buffer_load_dwordx4 v9, s[52:55], s76 offen offset:1024 lds
    s_add_u32 s76, s76, 6144
    buffer_load_dwordx4 v9, s[52:55], s76 offen offset:2048 lds
    s_add_u32 s76, s76, 6144
    buffer_load_dwordx4 v9, s[52:55], s76 offen offset:3072 lds
    s_mul_i32 s76, s9, 14
    s_add_u32 s76, s76, s25
    s_add_u32 s77, s24, 16384
    s_mov_b32 m0, s77
    s_nop 0
    buffer_load_dwordx4 v9, s[52:55], s76 offen offset:0 lds
    s_add_u32 s76, s76, 6144
    buffer_load_dwordx4 v9, s[52:55], s76 offen offset:1024 lds
    s_add_u32 s76, s76, 6144
    buffer_load_dwordx4 v9, s[52:55], s76 offen offset:2048 lds
    s_add_u32 s76, s76, 6144
    buffer_load_dwordx4 v9, s[52:55], s76 offen offset:3072 lds
    s_add_u32 s76, s29, 2
    s_add_u32 s80, s29, -5
    s_min_u32 s76, s76, s80
    s_mul_i32 s76, s76, 229376
    s_add_u32 s76, s76, s81
    s_add_u32 s76, s76, 128
    s_add_u32 s77, s82, 131072
    s_mov_b32 m0, s77
    s_nop 0
    buffer_load_dwordx4 v10, s[48:51], s76 offen offset:0 lds
    s_add_u32 s76, s76, 27648
    buffer_load_dwordx4 v10, s[48:51], s76 offen offset:1024 lds
    s_waitcnt vmcnt(6)
    ds_read_b64_tr_b16 v[160:161], v24 offset:0
    ds_read_b64_tr_b16 v[162:163], v24 offset:1024
    ds_read_b64_tr_b16 v[168:169], v25 offset:0
    ds_read_b64_tr_b16 v[170:171], v25 offset:1024
    ds_read_b64_tr_b16 v[164:165], v24 offset:32
    ds_read_b64_tr_b16 v[166:167], v24 offset:1056
    ds_read_b64_tr_b16 v[172:173], v25 offset:32
    ds_read_b64_tr_b16 v[174:175], v25 offset:1056
    s_waitcnt lgkmcnt(0)
    s_mul_i32 s76, s10, 14
    s_add_u32 s76, s76, s25
    s_add_u32 s77, s24, 0
    s_mov_b32 m0, s77
    s_nop 0
    buffer_load_dwordx4 v9, s[52:55], s76 offen offset:0 lds
    s_add_u32 s76, s76, 6144
    buffer_load_dwordx4 v9, s[52:55], s76 offen offset:1024 lds
    s_add_u32 s76, s76, 6144
    buffer_load_dwordx4 v9, s[52:55], s76 offen offset:2048 lds
    s_add_u32 s76, s76, 6144
    buffer_load_dwordx4 v9, s[52:55], s76 offen offset:3072 lds
    s_mov_b64 exec, 1
    ds_add_u32 v31, v11 offset:24
    s_mov_b64 exec, -1
    s_mul_i32 s88, s86, 114688
    s_add_u32 s88, s88, 8388608
    s_xor_b32 s76, s86, 1
    s_mul_i32 s89, s76, 114688
    s_add_u32 s89, s89, 8388608
    s_lshr_b32 s76, s86, 1
    s_lshl_b32 s76, s76, 2
    s_add_u32 s76, s76, s6
    s_lshl_b32 s76, s76, 9
    s_add_u32 s85, s76, 65536
    s_lshl_b32 s76, s4, 2
    s_add_u32 s73, s76, s6
    s_mul_i32 s83, s73, 114688
    s_lshl_b32 s76, s5, 13
    s_add_u32 s83, s83, s76
    s_add_u32 s83, s83, 8388608
    s_mul_i32 s70, s73, 3584
    s_add_u32 s70, s70, 6291456
    s_bfe_u32 s77, s73, 65537
    s_mul_i32 s78, s97, 7
    s_add_u32 s78, s78, 1
    s_lshr_b32 s78, s78, 1
    s_sub_u32 s76, s5, s78
    s_add_u32 s77, s76, 14
    s_min_u32 s76, s76, s77
    s_add_u32 s76, s76, 0
    s_and_b32 s77, s76, 3
    s_lshr_b32 s78, s73, 1
    s_lshl_b32 s78, s78, 2
    s_add_u32 s77, s77, s78
    s_lshl_b32 s77, s77, 2
    s_cmp_ge_u32 s76, 28
    s_addc_u32 s77, s77, 0
    s_cmp_ge_u32 s76, 40
    s_addc_u32 s77, s77, 0
    s_lshl_b32 s77, s77, 7
    s_add_u32 s22, s77, 65536
    s_lshl_b32 s76, s6, 2
    v_add_u32 v18, s76, v31
    s_lshl_b32 s76, s6, 9
    s_add_u32 s76, s76, 158720
    v_lshlrev_b32 v19, 4, v2
    v_add_u32 v19, s76, v19
    v_add_u32 v16, s24, v5
    v_lshlrev_b32 v26, 3, v1
    v_add_u32 v27, 147456, v5
    v_and_b32 v20, 15, v1
    v_mul_u32_u24 v20, 896, v20
    v_lshl_add_u32 v20, v3, 4, v20
    v_bfe_u32 v14, v1, 4, 1
    v_lshl_add_u32 v20, v14, 5, v20
    v_and_b32 v21, 1, v1
    v_lshlrev_b32 v21, 1, v21
    v_add_u32 v21, 6, v21
    s_add_u32 s76, s29, 3
    s_add_u32 s80, s29, -4
    s_min_u32 s76, s76, s80
    s_mul_i32 s76, s76, 229376
    s_add_u32 s76, s76, s81
    s_add_u32 s76, s76, 128
    s_add_u32 s77, s82, 139264
    s_mov_b32 m0, s77
    s_nop 0
    buffer_load_dwordx4 v10, s[48:51], s76 offen offset:0 lds
    s_add_u32 s76, s76, 27648
    buffer_load_dwordx4 v10, s[48:51], s76 offen offset:1024 lds
    s_waitcnt vmcnt(8)
    ds_read_b64_tr_b16 v[176:177], v24 offset:16384
    ds_read_b64_tr_b16 v[178:179], v24 offset:17408
    ds_read_b64_tr_b16 v[184:185], v25 offset:16384
    ds_read_b64_tr_b16 v[186:187], v25 offset:17408
    ds_read_b64_tr_b16 v[180:181], v24 offset:16416
    ds_read_b64_tr_b16 v[182:183], v24 offset:17440
    ds_read_b64_tr_b16 v[188:189], v25 offset:16416
    ds_read_b64_tr_b16 v[190:191], v25 offset:17440
    s_waitcnt lgkmcnt(0)
    s_mul_i32 s76, s11, 14
    s_add_u32 s76, s76, s25
    s_add_u32 s77, s24, 16384
    s_mov_b32 m0, s77
    s_nop 0
    buffer_load_dwordx4 v9, s[52:55], s76 offen offset:0 lds
    s_add_u32 s76, s76, 6144
    buffer_load_dwordx4 v9, s[52:55], s76 offen offset:1024 lds
    s_add_u32 s76, s76, 6144
    buffer_load_dwordx4 v9, s[52:55], s76 offen offset:2048 lds
    s_add_u32 s76, s76, 6144
    buffer_load_dwordx4 v9, s[52:55], s76 offen offset:3072 lds
    s_waitcnt vmcnt(6)
    ds_read_b64_tr_b16 v[192:193], v24 offset:0
    ds_read_b64_tr_b16 v[194:195], v24 offset:1024
    ds_read_b64_tr_b16 v[200:201], v25 offset:0
    ds_read_b64_tr_b16 v[202:203], v25 offset:1024
    ds_read_b64_tr_b16 v[196:197], v24 offset:32
    ds_read_b64_tr_b16 v[198:199], v24 offset:1056
    ds_read_b64_tr_b16 v[204:205], v25 offset:32
    ds_read_b64_tr_b16 v[206:207], v25 offset:1056
    s_waitcnt lgkmcnt(0)
    s_mul_i32 s76, s12, 14
    s_add_u32 s76, s76, s25
    s_add_u32 s77, s24, 0
    s_mov_b32 m0, s77
    s_nop 0
    buffer_load_dwordx4 v9, s[52:55], s76 offen offset:0 lds
    s_add_u32 s76, s76, 6144
    buffer_load_dwordx4 v9, s[52:55], s76 offen offset:1024 lds
    s_add_u32 s76, s76, 6144
    buffer_load_dwordx4 v9, s[52:55], s76 offen offset:2048 lds
    s_add_u32 s76, s76, 6144
    buffer_load_dwordx4 v9, s[52:55], s76 offen offset:3072 lds
    s_waitcnt vmcnt(4)
    ds_read_b64_tr_b16 v[208:209], v24 offset:16384
    ds_read_b64_tr_b16 v[210:211], v24 offset:17408
    ds_read_b64_tr_b16 v[216:217], v25 offset:16384
    ds_read_b64_tr_b16 v[218:219], v25 offset:17408
    ds_read_b64_tr_b16 v[212:213], v24 offset:16416
    ds_read_b64_tr_b16 v[214:215], v24 offset:17440
    ds_read_b64_tr_b16 v[220:221], v25 offset:16416
    ds_read_b64_tr_b16 v[222:223], v25 offset:17440
    s_waitcnt lgkmcnt(0)
    s_mul_i32 s76, s13, 14
    s_add_u32 s76, s76, s25
    s_add_u32 s77, s24, 16384
    s_mov_b32 m0, s77
    s_nop 0
    buffer_load_dwordx4 v9, s[52:55], s76 offen offset:0 lds
    s_add_u32 s76, s76, 6144
    buffer_load_dwordx4 v9, s[52:55], s76 offen offset:1024 lds
    s_add_u32 s76, s76, 6144
    buffer_load_dwordx4 v9, s[52:55], s76 offen offset:2048 lds
    s_add_u32 s76, s76, 6144
    buffer_load_dwordx4 v9, s[52:55], s76 offen offset:3072 lds
    s_waitcnt vmcnt(4)
    ds_read_b64_tr_b16 v[224:225], v24 offset:0
    ds_read_b64_tr_b16 v[226:227], v24 offset:1024
    ds_read_b64_tr_b16 v[232:233], v25 offset:0
    ds_read_b64_tr_b16 v[234:235], v25 offset:1024
    ds_read_b64_tr_b16 v[228:229], v24 offset:32
    ds_read_b64_tr_b16 v[230:231], v24 offset:1056
    ds_read_b64_tr_b16 v[236:237], v25 offset:32
    ds_read_b64_tr_b16 v[238:239], v25 offset:1056
    s_waitcnt vmcnt(0)
    ds_read_b64_tr_b16 v[240:241], v24 offset:16384
    ds_read_b64_tr_b16 v[242:243], v24 offset:17408
    ds_read_b64_tr_b16 v[248:249], v25 offset:16384
    ds_read_b64_tr_b16 v[250:251], v25 offset:17408
    ds_read_b64_tr_b16 v[244:245], v24 offset:16416
    ds_read_b64_tr_b16 v[246:247], v24 offset:17440
    ds_read_b64_tr_b16 v[252:253], v25 offset:16416
    ds_read_b64_tr_b16 v[254:255], v25 offset:17440
L_lw_41:
    ds_read_b32 v13, v31 offset:28
    s_add_u32 s75, s75, 1
    s_waitcnt lgkmcnt(0)
    v_readfirstlane_b32 s80, v13
    s_nop 0
    s_cmp_ge_u32 s80, 4
    s_cbranch_scc1 L_lwd_42
    s_sleep 1
    s_cmp_lt_u32 s75, 200000
    s_cbranch_scc1 L_lw_41
L_lwd_42:
    s_sub_u32 s76, s24, 24576
    v_add_u32 v14, s76, v6
    ds_read_b64 v[64:65], v14 offset:0
    ds_read_b64 v[66:67], v14 offset:1024
    ds_read_b64 v[68:69], v14 offset:256
    ds_read_b64 v[70:71], v14 offset:1280
    s_mov_b64 exec, 1
    ds_add_u32 v31, v11 offset:4
    s_mov_b64 exec, -1
L_lw_43:
    ds_read_b32 v13, v31 offset:4
    s_add_u32 s75, s75, 1
    s_waitcnt lgkmcnt(0)
    v_readfirstlane_b32 s80, v13
    s_nop 0
    s_cmp_ge_u32 s80, 12
    s_cbranch_scc1 L_lwd_44
    s_cmp_lt_u32 s75, 200000
    s_cbranch_scc1 L_lw_43
L_lwd_44:
    s_lshl_b32 s27, s5, 9
    s_add_u32 s27, s27, 65920
    s_mov_b32 s79, 0
    s_atomic_add s79, s[30:31], s27 glc
    s_add_u32 s76, s29, 4
    s_add_u32 s80, s29, -3
    s_min_u32 s76, s76, s80
    s_mul_i32 s76, s76, 229376
    s_add_u32 s76, s76, s81
    s_add_u32 s76, s76, 128
    s_add_u32 s77, s82, 0
    s_mov_b32 m0, s77
    s_nop 0
    buffer_load_dwordx4 v10, s[48:51], s76 offen offset:0 lds
    s_add_u32 s76, s76, 27648
    buffer_load_dwordx4 v10, s[48:51], s76 offen offset:1024 lds
    s_add_u32 s76, s29, 5
    s_add_u32 s80, s29, -2
    s_min_u32 s76, s76, s80
    s_mul_i32 s76, s76, 229376
    s_add_u32 s76, s76, s81
    s_add_u32 s76, s76, 128
    s_add_u32 s77, s82, 8192
    s_mov_b32 m0, s77
    s_nop 0
    buffer_load_dwordx4 v10, s[48:51], s76 offen offset:0 lds
    s_add_u32 s76, s76, 27648
    buffer_load_dwordx4 v10, s[48:51], s76 offen offset:1024 lds
    s_add_u32 s76, s29, 6
    s_add_u32 s80, s29, -1
    s_min_u32 s76, s76, s80
    s_mul_i32 s76, s76, 229376
    s_add_u32 s76, s76, s81
    s_add_u32 s76, s76, 128
    s_add_u32 s77, s82, 16384
    s_mov_b32 m0, s77
    s_nop 0
    buffer_load_dwordx4 v10, s[48:51], s76 offen offset:0 lds
    s_add_u32 s76, s76, 27648
    buffer_load_dwordx4 v10, s[48:51], s76 offen offset:1024 lds
    v_lshlrev_b32 v32, 16, v64
    v_and_b32 v33, 0xffff0000, v64
    v_lshlrev_b32 v48, 16, v104
    v_and_b32 v49, 0xffff0000, v104
    v_lshlrev_b32 v34, 16, v65
    v_and_b32 v35, 0xffff0000, v65
    v_lshlrev_b32 v50, 16, v105
    v_and_b32 v51, 0xffff0000, v105
    v_lshlrev_b32 v36, 16, v66
    v_and_b32 v37, 0xffff0000, v66
    v_lshlrev_b32 v52, 16, v106
    v_and_b32 v53, 0xffff0000, v106
    v_lshlrev_b32 v38, 16, v67
    v_and_b32 v39, 0xffff0000, v67
    v_lshlrev_b32 v54, 16, v107
    v_and_b32 v55, 0xffff0000, v107
    v_lshlrev_b32 v40, 16, v68
    v_and_b32 v41, 0xffff0000, v68
    v_lshlrev_b32 v56, 16, v104
    v_and_b32 v57, 0xffff0000, v104
    v_lshlrev_b32 v42, 16, v69
    v_and_b32 v43, 0xffff0000, v69
    v_lshlrev_b32 v58, 16, v105
    v_and_b32 v59, 0xffff0000, v105
    v_lshlrev_b32 v44, 16, v70
    v_and_b32 v45, 0xffff0000, v70
    v_lshlrev_b32 v60, 16, v106
    v_and_b32 v61, 0xffff0000, v106
    v_lshlrev_b32 v46, 16, v71
    v_and_b32 v47, 0xffff0000, v71
    v_lshlrev_b32 v62, 16, v107
    v_and_b32 v63, 0xffff0000, v107
    v_add_f32 v32, v32, v48
    v_add_f32 v33, v33, v49
    v_add_f32 v34, v34, v50
    v_add_f32 v35, v35, v51
    v_add_f32 v36, v36, v52
    v_add_f32 v37, v37, v53
    v_add_f32 v38, v38, v54
    v_add_f32 v39, v39, v55
    v_add_f32 v40, v40, v56
    v_add_f32 v41, v41, v57
    v_add_f32 v42, v42, v58
    v_add_f32 v43, v43, v59
    v_add_f32 v44, v44, v60
    v_add_f32 v45, v45, v61
    v_add_f32 v46, v46, v62
    v_add_f32 v47, v47, v63
    s_waitcnt lgkmcnt(0)
    s_cmp_ge_u32 s79, 8
    s_cbranch_scc1 L_eok
L_poll_45:
    s_mov_b32 s80, 0
    s_atomic_add s80, s[30:31], s27 glc
    s_add_u32 s75, s75, 1
    s_waitcnt lgkmcnt(0)
    s_cmp_ge_u32 s80, 8
    s_cbranch_scc1 L_pdone_46
    s_sleep 2
    s_cmp_lt_u32 s75, 200000
    s_cbranch_scc1 L_poll_45
L_pdone_46:
L_eok:
    s_lshl_b32 s76, s5, 12
    s_lshl_b32 s77, s6, 10
    s_add_u32 s76, s76, s77
    s_add_u32 s76, s76, 1572864
    v_add_u32 v100, s77, v27
    s_setprio 3
    buffer_load_dwordx4 v[96:99], v5, s[40:43], s76 offen sc1
L_lw_47:
    ds_read_b32 v13, v18 offset:80
    s_add_u32 s75, s75, 1
    s_waitcnt lgkmcnt(0)
    v_readfirstlane_b32 s80, v13
    s_nop 0
    s_cmp_ge_u32 s80, 1
    s_cbranch_scc1 L_lwd_48
    s_cmp_lt_u32 s75, 200000
    s_cbranch_scc1 L_lw_47
L_lwd_48:
    buffer_load_dwordx2 v[112:113], v26, s[40:43], s70 offen offset:0 sc1
    buffer_load_dwordx2 v[114:115], v26, s[40:43], s70 offen offset:512 sc1
    buffer_load_dwordx2 v[116:117], v26, s[40:43], s70 offen offset:1024 sc1
    buffer_load_dwordx2 v[118:119], v26, s[40:43], s70 offen offset:1536 sc1
    buffer_load_dwordx2 v[120:121], v26, s[40:43], s70 offen offset:2048 sc1
    buffer_load_dwordx2 v[122:123], v26, s[40:43], s70 offen offset:2560 sc1
    buffer_load_dwordx2 v[124:125], v26, s[40:43], s70 offen offset:3072 sc1
    s_waitcnt vmcnt(7)
    ds_write_b128 v100, v[96:99]
    s_mov_b64 exec, 1
    ds_add_u32 v31, v11 offset:20
    s_mov_b64 exec, -1
    s_waitcnt vmcnt(0)
    v_add_f32 v112, v112, v114
    v_add_f32 v113, v113, v115
    v_add_f32 v112, v112, v116
    v_add_f32 v113, v113, v117
    v_add_f32 v112, v112, v118
    v_add_f32 v113, v113, v119
    v_add_f32 v112, v112, v120
    v_add_f32 v113, v113, v121
    v_add_f32 v112, v112, v122
    v_add_f32 v113, v113, v123
    v_add_f32 v112, v112, v124
    v_add_f32 v113, v113, v125
    v_mov_b32 v14, v112
    v_mov_b32 v15, v113
    v_mov_b32 v115, 0x3727c5ac
    v_permlane32_swap_b32 v112, v14
    v_permlane32_swap_b32 v113, v15
    v_add_f32 v112, v112, v14
    v_add_f32 v113, v113, v15
    v_mul_f32 v114, 0xbb124925, v112
    v_mov_b32 v15, 0x3b124925
    v_mul_f32 v14, v114, v114
    v_fma_f32 v14, v113, v15, -v14
    v_max_f32 v14, 0, v14
    v_add_f32 v15, v115, v14
    v_fma_f32 v14, v15, v115, v14
    v_sqrt_f32 v90, v14
    v_rsq_f32 v115, v14
    v_cvt_pk_bf16_f32 v14, v114, v114
    v_and_b32 v14, 0xffff0000, v14
    v_sub_f32 v14, v114, v14
    v_cvt_pk_bf16_f32 v92, v114, v14
    v_cvt_pk_bf16_f32 v93, v114, v90
    v_mov_b32 v94, v92
    v_and_b32 v14, 0xffff0000, v93
    v_sub_f32 v14, v90, v14
    v_cvt_pk_bf16_f32 v95, v114, v14
    v_mul_f32 v88, 0xc0135761, v115
    v_mul_f32 v14, v115, v115
    v_mul_f32 v89, v88, v14
    v_mul_f32 v89, 0x3d372713, v89
    ds_write_b128 v19, v[88:91]
    ds_write_b128 v19, v[92:95] offset:2048
L_lw_49:
    ds_read_b32 v13, v31 offset:20
    s_add_u32 s75, s75, 1
    s_waitcnt lgkmcnt(0)
    v_readfirstlane_b32 s80, v13
    s_nop 0
    s_cmp_ge_u32 s80, 4
    s_cbranch_scc1 L_lwd_50
    s_cmp_lt_u32 s75, 200000
    s_cbranch_scc1 L_lw_49
L_lwd_50:
    s_mov_b64 exec, 1
    ds_add_u32 v18, v11 offset:96
    s_mov_b64 exec, -1
    s_xor_b32 s76, s6, 1
    s_lshl_b32 s76, s76, 12
    s_add_u32 s76, s76, 24576
    v_add_u32 v17, s76, v5
    s_xor_b32 s76, s6, 2
    s_lshl_b32 s76, s76, 12
    s_add_u32 s76, s76, 40960
    v_add_u32 v22, s76, v5
    s_xor_b32 s76, s6, 3
    s_lshl_b32 s76, s76, 12
    s_add_u32 s76, s76, 57344
    v_add_u32 v23, s76, v5
    s_mul_i32 s76, s14, 14
    s_add_u32 s76, s76, s25
    s_add_u32 s77, s24, 16384
    s_mov_b32 m0, s77
    s_nop 0
    buffer_load_dwordx4 v9, s[52:55], s76 offen offset:0 lds
    s_add_u32 s76, s76, 6144
    buffer_load_dwordx4 v9, s[52:55], s76 offen offset:1024 lds
    s_add_u32 s76, s76, 6144
    buffer_load_dwordx4 v9, s[52:55], s76 offen offset:2048 lds
    s_add_u32 s76, s76, 6144
    buffer_load_dwordx4 v9, s[52:55], s76 offen offset:3072 lds
L_lw_51:
    ds_read_b32 v13, v18 offset:32
    s_add_u32 s75, s75, 1
    s_waitcnt lgkmcnt(0)
    v_readfirstlane_b32 s80, v13
    s_nop 0
    s_cmp_ge_u32 s80, 1
    s_cbranch_scc1 L_lwd_52
    s_cmp_lt_u32 s75, 200000
    s_cbranch_scc1 L_lw_51
L_lwd_52:
    ds_read_b128 v[48:51], v16 offset:0
    ds_read_b128 v[52:55], v16 offset:1024
    ds_read_b128 v[56:59], v16 offset:2048
    ds_read_b128 v[60:63], v16 offset:3072
    s_waitcnt lgkmcnt(0)
    v_pk_mul_f32 v[80:81], v[48:49], v[48:49]
    v_pk_mul_f32 v[82:83], v[50:51], v[50:51]
    v_pk_mul_f32 v[84:85], v[52:53], v[52:53]
    v_pk_mul_f32 v[86:87], v[54:55], v[54:55]
    v_pk_fma_f32 v[80:81], v[80:81], v[88:89], v[88:89] op_sel:[0,1,0] op_sel_hi:[1,1,0]
    v_pk_fma_f32 v[82:83], v[82:83], v[88:89], v[88:89] op_sel:[0,1,0] op_sel_hi:[1,1,0]
    v_pk_fma_f32 v[84:85], v[84:85], v[88:89], v[88:89] op_sel:[0,1,0] op_sel_hi:[1,1,0]
    v_pk_fma_f32 v[86:87], v[86:87], v[88:89], v[88:89] op_sel:[0,1,0] op_sel_hi:[1,1,0]
    v_pk_mul_f32 v[80:81], v[80:81], v[48:49]
    v_pk_mul_f32 v[82:83], v[82:83], v[50:51]
    v_pk_mul_f32 v[84:85], v[84:85], v[52:53]
    v_pk_mul_f32 v[86:87], v[86:87], v[54:55]
    v_exp_f32 v80, v80
    v_exp_f32 v81, v81
    v_exp_f32 v82, v82
    v_exp_f32 v83, v83
    v_exp_f32 v84, v84
    v_exp_f32 v85, v85
    v_exp_f32 v86, v86
    v_exp_f32 v87, v87
    v_pk_fma_f32 v[80:81], v[80:81], v[90:91], v[90:91] op_sel:[0,0,0] op_sel_hi:[1,0,0]
    v_pk_fma_f32 v[82:83], v[82:83], v[90:91], v[90:91] op_sel:[0,0,0] op_sel_hi:[1,0,0]
    v_pk_fma_f32 v[84:85], v[84:85], v[90:91], v[90:91] op_sel:[0,0,0] op_sel_hi:[1,0,0]
    v_pk_fma_f32 v[86:87], v[86:87], v[90:91], v[90:91] op_sel:[0,0,0] op_sel_hi:[1,0,0]
    v_rcp_f32 v80, v80
    v_rcp_f32 v81, v81
    v_rcp_f32 v82, v82
    v_rcp_f32 v83, v83
    v_rcp_f32 v84, v84
    v_rcp_f32 v85, v85
    v_rcp_f32 v86, v86
    v_rcp_f32 v87, v87
    v_pk_mul_f32 v[80:81], v[80:81], v[48:49]
    v_pk_mul_f32 v[82:83], v[82:83], v[50:51]
    v_pk_mul_f32 v[84:85], v[84:85], v[52:53]
    v_pk_mul_f32 v[86:87], v[86:87], v[54:55]
    v_cvt_pk_bf16_f32 v48, v80, v81
    v_cvt_pk_bf16_f32 v49, v82, v83
    v_cvt_pk_bf16_f32 v50, v84, v85
    v_cvt_pk_bf16_f32 v51, v86, v87
    v_pk_mul_f32 v[80:81], v[56:57], v[56:57]
    v_pk_mul_f32 v[82:83], v[58:59], v[58:59]
    v_pk_mul_f32 v[84:85], v[60:61], v[60:61]
    v_pk_mul_f32 v[86:87], v[62:63], v[62:63]
    v_pk_fma_f32 v[80:81], v[80:81], v[88:89], v[88:89] op_sel:[0,1,0] op_sel_hi:[1,1,0]
    v_pk_fma_f32 v[82:83], v[82:83], v[88:89], v[88:89] op_sel:[0,1,0] op_sel_hi:[1,1,0]
    v_pk_fma_f32 v[84:85], v[84:85], v[88:89], v[88:89] op_sel:[0,1,0] op_sel_hi:[1,1,0]
    v_pk_fma_f32 v[86:87], v[86:87], v[88:89], v[88:89] op_sel:[0,1,0] op_sel_hi:[1,1,0]
    v_pk_mul_f32 v[80:81], v[80:81], v[56:57]
    v_pk_mul_f32 v[82:83], v[82:83], v[58:59]
    v_pk_mul_f32 v[84:85], v[84:85], v[60:61]
    v_pk_mul_f32 v[86:87], v[86:87], v[62:63]
    v_exp_f32 v80, v80
    v_exp_f32 v81, v81
    v_exp_f32 v82, v82
    v_exp_f32 v83, v83
    v_exp_f32 v84, v84
    v_exp_f32 v85, v85
    v_exp_f32 v86, v86
    v_exp_f32 v87, v87
    v_pk_fma_f32 v[80:81], v[80:81], v[90:91], v[90:91] op_sel:[0,0,0] op_sel_hi:[1,0,0]
    v_pk_fma_f32 v[82:83], v[82:83], v[90:91], v[90:91] op_sel:[0,0,0] op_sel_hi:[1,0,0]
    v_pk_fma_f32 v[84:85], v[84:85], v[90:91], v[90:91] op_sel:[0,0,0] op_sel_hi:[1,0,0]
    v_pk_fma_f32 v[86:87], v[86:87], v[90:91], v[90:91] op_sel:[0,0,0] op_sel_hi:[1,0,0]
    v_rcp_f32 v80, v80
    v_rcp_f32 v81, v81
    v_rcp_f32 v82, v82
    v_rcp_f32 v83, v83
    v_rcp_f32 v84, v84
    v_rcp_f32 v85, v85
    v_rcp_f32 v86, v86
    v_rcp_f32 v87, v87
    v_pk_mul_f32 v[80:81], v[80:81], v[56:57]
    v_pk_mul_f32 v[82:83], v[82:83], v[58:59]
    v_pk_mul_f32 v[84:85], v[84:85], v[60:61]
    v_pk_mul_f32 v[86:87], v[86:87], v[62:63]
    v_cvt_pk_bf16_f32 v52, v80, v81
    v_cvt_pk_bf16_f32 v53, v82, v83
    v_cvt_pk_bf16_f32 v54, v84, v85
    v_cvt_pk_bf16_f32 v55, v86, v87
    s_add_u32 s76, s83, 0
    buffer_store_dwordx4 v[48:51], v5, s[40:43], s76 offen sc1
    buffer_store_dwordx4 v[52:55], v5, s[40:43], s76 offen offset:1024 sc1
    s_setprio 0
    s_mul_i32 s76, s15, 14
    s_add_u32 s76, s76, s25
    s_add_u32 s77, s24, 0
    s_mov_b32 m0, s77
    s_nop 0
    buffer_load_dwordx4 v9, s[52:55], s76 offen offset:0 lds
    s_add_u32 s76, s76, 6144
    buffer_load_dwordx4 v9, s[52:55], s76 offen offset:1024 lds
    s_add_u32 s76, s76, 6144
    buffer_load_dwordx4 v9, s[52:55], s76 offen offset:2048 lds
    s_add_u32 s76, s76, 6144
    buffer_load_dwordx4 v9, s[52:55], s76 offen offset:3072 lds
L_lw_53:
    ds_read_b32 v13, v31 offset:48
    s_add_u32 s75, s75, 1
    s_waitcnt lgkmcnt(0)
    v_readfirstlane_b32 s80, v13
    s_nop 0
    s_cmp_ge_u32 s80, 4
    s_cbranch_scc1 L_lwd_54
    s_cmp_lt_u32 s75, 200000
    s_cbranch_scc1 L_lw_53
L_lwd_54:
    s_mul_i32 s76, s16, 14
    s_add_u32 s76, s76, s25
    s_add_u32 s77, s24, 32768
    s_mov_b32 m0, s77
    s_nop 0
    buffer_load_dwordx4 v9, s[52:55], s76 offen offset:0 lds
    s_add_u32 s76, s76, 6144
    buffer_load_dwordx4 v9, s[52:55], s76 offen offset:1024 lds
    s_add_u32 s76, s76, 6144
    buffer_load_dwordx4 v9, s[52:55], s76 offen offset:2048 lds
    s_add_u32 s76, s76, 6144
    buffer_load_dwordx4 v9, s[52:55], s76 offen offset:3072 lds
    s_waitcnt vmcnt(8)
    s_mov_b64 exec, 1
    buffer_atomic_add v11, off, s[40:43], s22
    s_mov_b64 exec, -1
    s_mul_i32 s76, s17, 14
    s_add_u32 s76, s76, s25
    s_add_u32 s77, s24, 49152
    s_mov_b32 m0, s77
    s_nop 0
    buffer_load_dwordx4 v9, s[52:55], s76 offen offset:0 lds
    s_add_u32 s76, s76, 6144
    buffer_load_dwordx4 v9, s[52:55], s76 offen offset:1024 lds
    s_add_u32 s76, s76, 6144
    buffer_load_dwordx4 v9, s[52:55], s76 offen offset:2048 lds
    s_add_u32 s76, s76, 6144
    buffer_load_dwordx4 v9, s[52:55], s76 offen offset:3072 lds
    s_mul_i32 s76, s18, 14
    s_add_u32 s76, s76, s25
    s_add_u32 s77, s24, 65536
    s_mov_b32 m0, s77
    s_nop 0
    buffer_load_dwordx4 v9, s[52:55], s76 offen offset:0 lds
    s_add_u32 s76, s76, 6144
    buffer_load_dwordx4 v9, s[52:55], s76 offen offset:1024 lds
    s_add_u32 s76, s76, 6144
    buffer_load_dwordx4 v9, s[52:55], s76 offen offset:2048 lds
    s_add_u32 s76, s76, 6144
    buffer_load_dwordx4 v9, s[52:55], s76 offen offset:3072 lds
L_lw_55:
    ds_read_b32 v13, v31 offset:52
    s_add_u32 s75, s75, 1
    s_waitcnt lgkmcnt(0)
    v_readfirstlane_b32 s80, v13
    s_nop 0
    s_cmp_ge_u32 s80, 4
    s_cbranch_scc1 L_lwd_56
    s_sleep 1
    s_cmp_lt_u32 s75, 200000
    s_cbranch_scc1 L_lw_55
L_lwd_56:
    s_add_u32 s26, s85, 0
    s_mov_b32 s71, 0
    s_atomic_add s71, s[30:31], s26 glc
    s_mul_i32 s76, s19, 14
    s_add_u32 s76, s76, s25
    s_add_u32 s77, s24, 81920
    s_mov_b32 m0, s77
    s_nop 0
    buffer_load_dwordx4 v9, s[52:55], s76 offen offset:0 lds
    s_add_u32 s76, s76, 6144
    buffer_load_dwordx4 v9, s[52:55], s76 offen offset:1024 lds
    s_add_u32 s76, s76, 6144
    buffer_load_dwordx4 v9, s[52:55], s76 offen offset:2048 lds
    s_add_u32 s76, s76, 6144
    buffer_load_dwordx4 v9, s[52:55], s76 offen offset:3072 lds
    s_waitcnt lgkmcnt(0)
    s_cmp_ge_u32 s71, 14
    s_cbranch_scc1 L_go_57
L_poll_58:
    s_mov_b32 s80, 0
    s_atomic_add s80, s[30:31], s26 glc
    s_add_u32 s75, s75, 1
    s_waitcnt lgkmcnt(0)
    s_cmp_ge_u32 s80, 14
    s_cbranch_scc1 L_pdone_59
    s_cmp_lt_u32 s75, 200000
    s_cbranch_scc1 L_poll_58
L_pdone_59:
L_go_57:
    s_add_u32 s77, s8, s89
    s_add_u32 s76, s8, s88
    buffer_load_dwordx4 v[96:99], v30, s[40:43], s76 offen offset:0 sc1
    buffer_load_dwordx4 v[104:107], v30, s[40:43], s77 offen offset:0 sc1
    buffer_load_dwordx4 v[100:103], v30, s[40:43], s76 offen offset:256 sc1
    buffer_load_dwordx4 v[108:111], v30, s[40:43], s77 offen offset:256 sc1
    s_add_u32 s77, s9, s89
    s_add_u32 s76, s9, s88
    buffer_load_dwordx4 v[112:115], v30, s[40:43], s76 offen offset:0 sc1
    buffer_load_dwordx4 v[120:123], v30, s[40:43], s77 offen offset:0 sc1
    buffer_load_dwordx4 v[116:119], v30, s[40:43], s76 offen offset:256 sc1
    buffer_load_dwordx4 v[124:127], v30, s[40:43], s77 offen offset:256 sc1
    s_add_u32 s77, s10, s89
    s_add_u32 s76, s10, s88
    buffer_load_dwordx4 v[128:131], v30, s[40:43], s76 offen offset:0 sc1
    buffer_load_dwordx4 v[136:139], v30, s[40:43], s77 offen offset:0 sc1
    buffer_load_dwordx4 v[132:135], v30, s[40:43], s76 offen offset:256 sc1
    buffer_load_dwordx4 v[140:143], v30, s[40:43], s77 offen offset:256 sc1
    s_add_u32 s77, s11, s89
    s_add_u32 s76, s11, s88
    buffer_load_dwordx4 v[144:147], v30, s[40:43], s76 offen offset:0 sc1
    buffer_load_dwordx4 v[152:155], v30, s[40:43], s77 offen offset:0 sc1
    buffer_load_dwordx4 v[148:151], v30, s[40:43], s76 offen offset:256 sc1
    buffer_load_dwordx4 v[156:159], v30, s[40:43], s77 offen offset:256 sc1
    s_setprio 0
    s_mov_b32 s98, 0
    s_mov_b32 s99, 0
    s_add_u32 s26, s85, 128
    s_add_u32 s27, s85, 256
    s_cmp_ge_u32 s98, 6
    s_cbranch_scc1 L_sm_60
    s_atomic_umax s98, s[30:31], s26 glc
L_sm_60:
    s_waitcnt vmcnt(12)
    v_mfma_f32_16x16x32_bf16 v[32:35], v[160:163], v[96:99], v[32:35]
    v_mfma_f32_16x16x32_bf16 v[36:39], v[164:167], v[96:99], v[36:39]
    v_mfma_f32_16x16x32_bf16 v[48:51], v[160:163], v[104:107], 0
    v_mfma_f32_16x16x32_bf16 v[52:55], v[164:167], v[104:107], 0
    s_mul_i32 s78, s20, 14
    s_add_u32 m0, s24, 98304
    s_add_u32 s78, s78, s25
    buffer_load_dwordx4 v9, s[52:55], s78 offen offset:0 lds
    v_mfma_f32_16x16x32_bf16 v[64:67], v[168:171], v[96:99], 0
    v_mfma_f32_16x16x32_bf16 v[68:71], v[172:175], v[96:99], 0
    v_mfma_f32_16x16x32_bf16 v[80:83], v[168:171], v[104:107], 0
    v_mfma_f32_16x16x32_bf16 v[84:87], v[172:175], v[104:107], 0
    s_add_u32 s78, s78, 6144
    buffer_load_dwordx4 v9, s[52:55], s78 offen offset:1024 lds
    v_mfma_f32_16x16x32_bf16 v[40:43], v[160:163], v[100:103], v[40:43]
    v_mfma_f32_16x16x32_bf16 v[44:47], v[164:167], v[100:103], v[44:47]
    v_mfma_f32_16x16x32_bf16 v[56:59], v[160:163], v[108:111], 0
    v_mfma_f32_16x16x32_bf16 v[60:63], v[164:167], v[108:111], 0
    s_add_u32 s78, s78, 6144
    buffer_load_dwordx4 v9, s[52:55], s78 offen offset:2048 lds
    v_mfma_f32_16x16x32_bf16 v[72:75], v[168:171], v[100:103], 0
    v_mfma_f32_16x16x32_bf16 v[76:79], v[172:175], v[100:103], 0
    v_mfma_f32_16x16x32_bf16 v[88:91], v[168:171], v[108:111], 0
    v_mfma_f32_16x16x32_bf16 v[92:95], v[172:175], v[108:111], 0
    s_add_u32 s78, s78, 6144
    buffer_load_dwordx4 v9, s[52:55], s78 offen offset:3072 lds
    ds_read_b64_tr_b16 v[160:161], v24 offset:16384
    ds_read_b64_tr_b16 v[162:163], v24 offset:17408
    ds_read_b64_tr_b16 v[168:169], v25 offset:16384
    ds_read_b64_tr_b16 v[170:171], v25 offset:17408
    ds_read_b64_tr_b16 v[164:165], v24 offset:16416
    ds_read_b64_tr_b16 v[166:167], v24 offset:17440
    ds_read_b64_tr_b16 v[172:173], v25 offset:16416
    ds_read_b64_tr_b16 v[174:175], v25 offset:17440
    s_add_u32 s77, s12, s89
    s_add_u32 s76, s12, s88
    buffer_load_dwordx4 v[96:99], v30, s[40:43], s76 offen offset:0 sc1
    buffer_load_dwordx4 v[104:107], v30, s[40:43], s77 offen offset:0 sc1
    buffer_load_dwordx4 v[100:103], v30, s[40:43], s76 offen offset:256 sc1
    buffer_load_dwordx4 v[108:111], v30, s[40:43], s77 offen offset:256 sc1
    s_cmp_ge_u32 s98, 6
    s_cbranch_scc1 L_sm_61
    s_atomic_umax s98, s[30:31], s26 glc
L_sm_61:
    s_waitcnt vmcnt(16)
    v_mfma_f32_16x16x32_bf16 v[32:35], v[176:179], v[112:115], v[32:35]
    v_mfma_f32_16x16x32_bf16 v[36:39], v[180:183], v[112:115], v[36:39]
    v_mfma_f32_16x16x32_bf16 v[48:51], v[176:179], v[120:123], v[48:51]
    v_mfma_f32_16x16x32_bf16 v[52:55], v[180:183], v[120:123], v[52:55]
    s_mul_i32 s78, s21, 14
    s_add_u32 m0, s24, 114688
    s_add_u32 s78, s78, s25
    buffer_load_dwordx4 v9, s[52:55], s78 offen offset:0 lds
    v_mfma_f32_16x16x32_bf16 v[64:67], v[184:187], v[112:115], v[64:67]
    v_mfma_f32_16x16x32_bf16 v[68:71], v[188:191], v[112:115], v[68:71]
    v_mfma_f32_16x16x32_bf16 v[80:83], v[184:187], v[120:123], v[80:83]
    v_mfma_f32_16x16x32_bf16 v[84:87], v[188:191], v[120:123], v[84:87]
    s_add_u32 s78, s78, 6144
    buffer_load_dwordx4 v9, s[52:55], s78 offen offset:1024 lds
    v_mfma_f32_16x16x32_bf16 v[40:43], v[176:179], v[116:119], v[40:43]
    v_mfma_f32_16x16x32_bf16 v[44:47], v[180:183], v[116:119], v[44:47]
    v_mfma_f32_16x16x32_bf16 v[56:59], v[176:179], v[124:127], v[56:59]
    v_mfma_f32_16x16x32_bf16 v[60:63], v[180:183], v[124:127], v[60:63]
    s_add_u32 s78, s78, 6144
    buffer_load_dwordx4 v9, s[52:55], s78 offen offset:2048 lds
    v_mfma_f32_16x16x32_bf16 v[72:75], v[184:187], v[116:119], v[72:75]
    v_mfma_f32_16x16x32_bf16 v[76:79], v[188:191], v[116:119], v[76:79]
    v_mfma_f32_16x16x32_bf16 v[88:91], v[184:187], v[124:127], v[88:91]
    v_mfma_f32_16x16x32_bf16 v[92:95], v[188:191], v[124:127], v[92:95]
    s_add_u32 s78, s78, 6144
    buffer_load_dwordx4 v9, s[52:55], s78 offen offset:3072 lds
    ds_read_b64_tr_b16 v[176:177], v24 offset:0
    ds_read_b64_tr_b16 v[178:179], v24 offset:1024
    ds_read_b64_tr_b16 v[184:185], v25 offset:0
    ds_read_b64_tr_b16 v[186:187], v25 offset:1024
    ds_read_b64_tr_b16 v[180:181], v24 offset:32
    ds_read_b64_tr_b16 v[182:183], v24 offset:1056
    ds_read_b64_tr_b16 v[188:189], v25 offset:32
    ds_read_b64_tr_b16 v[190:191], v25 offset:1056
    s_add_u32 s77, s13, s89
    s_add_u32 s76, s13, s88
    buffer_load_dwordx4 v[112:115], v30, s[40:43], s76 offen offset:0 sc1
    buffer_load_dwordx4 v[120:123], v30, s[40:43], s77 offen offset:0 sc1
    buffer_load_dwordx4 v[116:119], v30, s[40:43], s76 offen offset:256 sc1
    buffer_load_dwordx4 v[124:127], v30, s[40:43], s77 offen offset:256 sc1
    s_cmp_ge_u32 s98, 6
    s_cbranch_scc1 L_sm_62
    s_atomic_umax s98, s[30:31], s26 glc
L_sm_62:
    s_waitcnt vmcnt(20)
    v_mfma_f32_16x16x32_bf16 v[32:35], v[192:195], v[128:131], v[32:35]
    v_mfma_f32_16x16x32_bf16 v[36:39], v[196:199], v[128:131], v[36:39]
    v_mfma_f32_16x16x32_bf16 v[48:51], v[192:195], v[136:139], v[48:51]
    v_mfma_f32_16x16x32_bf16 v[52:55], v[196:199], v[136:139], v[52:55]
    v_mfma_f32_16x16x32_bf16 v[64:67], v[200:203], v[128:131], v[64:67]
    v_mfma_f32_16x16x32_bf16 v[68:71], v[204:207], v[128:131], v[68:71]
    v_mfma_f32_16x16x32_bf16 v[80:83], v[200:203], v[136:139], v[80:83]
    v_mfma_f32_16x16x32_bf16 v[84:87], v[204:207], v[136:139], v[84:87]
    v_mfma_f32_16x16x32_bf16 v[40:43], v[192:195], v[132:135], v[40:43]
    v_mfma_f32_16x16x32_bf16 v[44:47], v[196:199], v[132:135], v[44:47]
    v_mfma_f32_16x16x32_bf16 v[56:59], v[192:195], v[140:143], v[56:59]
    v_mfma_f32_16x16x32_bf16 v[60:63], v[196:199], v[140:143], v[60:63]
    v_mfma_f32_16x16x32_bf16 v[72:75], v[200:203], v[132:135], v[72:75]
    v_mfma_f32_16x16x32_bf16 v[76:79], v[204:207], v[132:135], v[76:79]
    v_mfma_f32_16x16x32_bf16 v[88:91], v[200:203], v[140:143], v[88:91]
    v_mfma_f32_16x16x32_bf16 v[92:95], v[204:207], v[140:143], v[92:95]
    ds_read_b64_tr_b16 v[192:193], v24 offset:32768
    ds_read_b64_tr_b16 v[194:195], v24 offset:33792
    ds_read_b64_tr_b16 v[200:201], v25 offset:32768
    ds_read_b64_tr_b16 v[202:203], v25 offset:33792
    ds_read_b64_tr_b16 v[196:197], v24 offset:32800
    ds_read_b64_tr_b16 v[198:199], v24 offset:33824
    ds_read_b64_tr_b16 v[204:205], v25 offset:32800
    ds_read_b64_tr_b16 v[206:207], v25 offset:33824
    s_add_u32 s77, s14, s89
    s_add_u32 s76, s14, s88
    buffer_load_dwordx4 v[128:131], v30, s[40:43], s76 offen offset:0 sc1
    buffer_load_dwordx4 v[136:139], v30, s[40:43], s77 offen offset:0 sc1
    buffer_load_dwordx4 v[132:135], v30, s[40:43], s76 offen offset:256 sc1
    buffer_load_dwordx4 v[140:143], v30, s[40:43], s77 offen offset:256 sc1
    s_cmp_ge_u32 s98, 6
    s_cbranch_scc1 L_sm_63
    s_atomic_umax s98, s[30:31], s26 glc
L_sm_63:
    s_cmp_ge_u32 s99, 8
    s_cbranch_scc1 L_sm_64
    s_atomic_umax s99, s[30:31], s27 glc
L_sm_64:
    s_waitcnt vmcnt(20)
    v_mfma_f32_16x16x32_bf16 v[32:35], v[208:211], v[144:147], v[32:35]
    v_mfma_f32_16x16x32_bf16 v[36:39], v[212:215], v[144:147], v[36:39]
    v_mfma_f32_16x16x32_bf16 v[48:51], v[208:211], v[152:155], v[48:51]
    v_mfma_f32_16x16x32_bf16 v[52:55], v[212:215], v[152:155], v[52:55]
    v_mfma_f32_16x16x32_bf16 v[64:67], v[216:219], v[144:147], v[64:67]
    v_mfma_f32_16x16x32_bf16 v[68:71], v[220:223], v[144:147], v[68:71]
    v_mfma_f32_16x16x32_bf16 v[80:83], v[216:219], v[152:155], v[80:83]
    v_mfma_f32_16x16x32_bf16 v[84:87], v[220:223], v[152:155], v[84:87]
    v_mfma_f32_16x16x32_bf16 v[40:43], v[208:211], v[148:151], v[40:43]
    v_mfma_f32_16x16x32_bf16 v[44:47], v[212:215], v[148:151], v[44:47]
    v_mfma_f32_16x16x32_bf16 v[56:59], v[208:211], v[156:159], v[56:59]
    v_mfma_f32_16x16x32_bf16 v[60:63], v[212:215], v[156:159], v[60:63]
    v_mfma_f32_16x16x32_bf16 v[72:75], v[216:219], v[148:151], v[72:75]
    v_mfma_f32_16x16x32_bf16 v[76:79], v[220:223], v[148:151], v[76:79]
    v_mfma_f32_16x16x32_bf16 v[88:91], v[216:219], v[156:159], v[88:91]
    v_mfma_f32_16x16x32_bf16 v[92:95], v[220:223], v[156:159], v[92:95]
    ds_read_b64_tr_b16 v[208:209], v24 offset:49152
    ds_read_b64_tr_b16 v[210:211], v24 offset:50176
    ds_read_b64_tr_b16 v[216:217], v25 offset:49152
    ds_read_b64_tr_b16 v[218:219], v25 offset:50176
    ds_read_b64_tr_b16 v[212:213], v24 offset:49184
    ds_read_b64_tr_b16 v[214:215], v24 offset:50208
    ds_read_b64_tr_b16 v[220:221], v25 offset:49184
    ds_read_b64_tr_b16 v[222:223], v25 offset:50208
    s_cmp_ge_u32 s98, 6
    s_cbranch_scc1 L_g2_65
    s_waitcnt lgkmcnt(0)
    s_cmp_ge_u32 s98, 6
    s_cbranch_scc1 L_g2_65
L_poll_66:
    s_mov_b32 s80, 0
    s_atomic_add s80, s[30:31], s26 glc
    s_add_u32 s75, s75, 1
    s_waitcnt lgkmcnt(0)
    s_cmp_ge_u32 s80, 6
    s_cbranch_scc1 L_pdone_67
    s_cmp_lt_u32 s75, 200000
    s_cbranch_scc1 L_poll_66
L_pdone_67:
L_g2_65:
    s_add_u32 s77, s15, s89
    s_add_u32 s76, s15, s88
    buffer_load_dwordx4 v[144:147], v30, s[40:43], s76 offen offset:0 sc1
    buffer_load_dwordx4 v[152:155], v30, s[40:43], s77 offen offset:0 sc1
    buffer_load_dwordx4 v[148:151], v30, s[40:43], s76 offen offset:256 sc1
    buffer_load_dwordx4 v[156:159], v30, s[40:43], s77 offen offset:256 sc1
    s_cmp_ge_u32 s99, 8
    s_cbranch_scc1 L_sm_68
    s_atomic_umax s99, s[30:31], s27 glc
L_sm_68:
    s_waitcnt vmcnt(16)
    v_mfma_f32_16x16x32_bf16 v[32:35], v[224:227], v[96:99], v[32:35]
    v_mfma_f32_16x16x32_bf16 v[36:39], v[228:231], v[96:99], v[36:39]
    v_mfma_f32_16x16x32_bf16 v[48:51], v[224:227], v[104:107], v[48:51]
    v_mfma_f32_16x16x32_bf16 v[52:55], v[228:231], v[104:107], v[52:55]
    v_mfma_f32_16x16x32_bf16 v[64:67], v[232:235], v[96:99], v[64:67]
    v_mfma_f32_16x16x32_bf16 v[68:71], v[236:239], v[96:99], v[68:71]
    v_mfma_f32_16x16x32_bf16 v[80:83], v[232:235], v[104:107], v[80:83]
    v_mfma_f32_16x16x32_bf16 v[84:87], v[236:239], v[104:107], v[84:87]
    v_mfma_f32_16x16x32_bf16 v[40:43], v[224:227], v[100:103], v[40:43]
    v_mfma_f32_16x16x32_bf16 v[44:47], v[228:231], v[100:103], v[44:47]
    v_mfma_f32_16x16x32_bf16 v[56:59], v[224:227], v[108:111], v[56:59]
    v_mfma_f32_16x16x32_bf16 v[60:63], v[228:231], v[108:111], v[60:63]
    v_mfma_f32_16x16x32_bf16 v[72:75], v[232:235], v[100:103], v[72:75]
    v_mfma_f32_16x16x32_bf16 v[76:79], v[236:239], v[100:103], v[76:79]
    v_mfma_f32_16x16x32_bf16 v[88:91], v[232:235], v[108:111], v[88:91]
    v_mfma_f32_16x16x32_bf16 v[92:95], v[236:239], v[108:111], v[92:95]
    ds_read_b64_tr_b16 v[224:225], v28 offset:0
    ds_read_b64_tr_b16 v[226:227], v28 offset:1024
    ds_read_b64_tr_b16 v[232:233], v29 offset:0
    ds_read_b64_tr_b16 v[234:235], v29 offset:1024
    ds_read_b64_tr_b16 v[228:229], v28 offset:32
    ds_read_b64_tr_b16 v[230:231], v28 offset:1056
    ds_read_b64_tr_b16 v[236:237], v29 offset:32
    ds_read_b64_tr_b16 v[238:239], v29 offset:1056
    s_add_u32 s77, s16, s89
    s_add_u32 s76, s16, s88
    buffer_load_dwordx4 v[96:99], v30, s[40:43], s76 offen offset:0 sc1
    buffer_load_dwordx4 v[104:107], v30, s[40:43], s77 offen offset:0 sc1
    buffer_load_dwordx4 v[100:103], v30, s[40:43], s76 offen offset:256 sc1
    buffer_load_dwordx4 v[108:111], v30, s[40:43], s77 offen offset:256 sc1
    s_cmp_ge_u32 s99, 8
    s_cbranch_scc1 L_sm_69
    s_atomic_umax s99, s[30:31], s27 glc
L_sm_69:
    s_waitcnt vmcnt(12)
    v_mfma_f32_16x16x32_bf16 v[32:35], v[240:243], v[112:115], v[32:35]
    v_mfma_f32_16x16x32_bf16 v[36:39], v[244:247], v[112:115], v[36:39]
    v_mfma_f32_16x16x32_bf16 v[48:51], v[240:243], v[120:123], v[48:51]
    v_mfma_f32_16x16x32_bf16 v[52:55], v[244:247], v[120:123], v[52:55]
    v_mfma_f32_16x16x32_bf16 v[64:67], v[248:251], v[112:115], v[64:67]
    v_mfma_f32_16x16x32_bf16 v[68:71], v[252:255], v[112:115], v[68:71]
    v_mfma_f32_16x16x32_bf16 v[80:83], v[248:251], v[120:123], v[80:83]
    v_mfma_f32_16x16x32_bf16 v[84:87], v[252:255], v[120:123], v[84:87]
    v_mfma_f32_16x16x32_bf16 v[40:43], v[240:243], v[116:119], v[40:43]
    v_mfma_f32_16x16x32_bf16 v[44:47], v[244:247], v[116:119], v[44:47]
    v_mfma_f32_16x16x32_bf16 v[56:59], v[240:243], v[124:127], v[56:59]
    v_mfma_f32_16x16x32_bf16 v[60:63], v[244:247], v[124:127], v[60:63]
    v_mfma_f32_16x16x32_bf16 v[72:75], v[248:251], v[116:119], v[72:75]
    v_mfma_f32_16x16x32_bf16 v[76:79], v[252:255], v[116:119], v[76:79]
    v_mfma_f32_16x16x32_bf16 v[88:91], v[248:251], v[124:127], v[88:91]
    v_mfma_f32_16x16x32_bf16 v[92:95], v[252:255], v[124:127], v[92:95]
    ds_read_b64_tr_b16 v[240:241], v28 offset:16384
    ds_read_b64_tr_b16 v[242:243], v28 offset:17408
    ds_read_b64_tr_b16 v[248:249], v29 offset:16384
    ds_read_b64_tr_b16 v[250:251], v29 offset:17408
    ds_read_b64_tr_b16 v[244:245], v28 offset:16416
    ds_read_b64_tr_b16 v[246:247], v28 offset:17440
    ds_read_b64_tr_b16 v[252:253], v29 offset:16416
    ds_read_b64_tr_b16 v[254:255], v29 offset:17440
    s_add_u32 s77, s17, s89
    s_add_u32 s76, s17, s88
    buffer_load_dwordx4 v[112:115], v30, s[40:43], s76 offen offset:0 sc1
    buffer_load_dwordx4 v[120:123], v30, s[40:43], s77 offen offset:0 sc1
    buffer_load_dwordx4 v[116:119], v30, s[40:43], s76 offen offset:256 sc1
    buffer_load_dwordx4 v[124:127], v30, s[40:43], s77 offen offset:256 sc1
    s_cmp_ge_u32 s99, 8
    s_cbranch_scc1 L_sm_70
    s_atomic_umax s99, s[30:31], s27 glc
L_sm_70:
    s_waitcnt vmcnt(12) lgkmcnt(15)
    v_mfma_f32_16x16x32_bf16 v[32:35], v[160:163], v[128:131], v[32:35]
    v_mfma_f32_16x16x32_bf16 v[36:39], v[164:167], v[128:131], v[36:39]
    v_mfma_f32_16x16x32_bf16 v[48:51], v[160:163], v[136:139], v[48:51]
    v_mfma_f32_16x16x32_bf16 v[52:55], v[164:167], v[136:139], v[52:55]
    v_mfma_f32_16x16x32_bf16 v[64:67], v[168:171], v[128:131], v[64:67]
    v_mfma_f32_16x16x32_bf16 v[68:71], v[172:175], v[128:131], v[68:71]
    v_mfma_f32_16x16x32_bf16 v[80:83], v[168:171], v[136:139], v[80:83]
    v_mfma_f32_16x16x32_bf16 v[84:87], v[172:175], v[136:139], v[84:87]
    v_mfma_f32_16x16x32_bf16 v[40:43], v[160:163], v[132:135], v[40:43]
    v_mfma_f32_16x16x32_bf16 v[44:47], v[164:167], v[132:135], v[44:47]
    v_mfma_f32_16x16x32_bf16 v[56:59], v[160:163], v[140:143], v[56:59]
    v_mfma_f32_16x16x32_bf16 v[60:63], v[164:167], v[140:143], v[60:63]
    v_mfma_f32_16x16x32_bf16 v[72:75], v[168:171], v[132:135], v[72:75]
    v_mfma_f32_16x16x32_bf16 v[76:79], v[172:175], v[132:135], v[76:79]
    v_mfma_f32_16x16x32_bf16 v[88:91], v[168:171], v[140:143], v[88:91]
    v_mfma_f32_16x16x32_bf16 v[92:95], v[172:175], v[140:143], v[92:95]
    ds_read_b64_tr_b16 v[160:161], v28 offset:32768
    ds_read_b64_tr_b16 v[162:163], v28 offset:33792
    ds_read_b64_tr_b16 v[168:169], v29 offset:32768
    ds_read_b64_tr_b16 v[170:171], v29 offset:33792
    ds_read_b64_tr_b16 v[164:165], v28 offset:32800
    ds_read_b64_tr_b16 v[166:167], v28 offset:33824
    ds_read_b64_tr_b16 v[172:173], v29 offset:32800
    ds_read_b64_tr_b16 v[174:175], v29 offset:33824
    s_cmp_ge_u32 s99, 8
    s_cbranch_scc1 L_g2_71
    s_waitcnt lgkmcnt(0)
    s_cmp_ge_u32 s99, 8
    s_cbranch_scc1 L_g2_71
L_poll_72:
    s_mov_b32 s80, 0
    s_atomic_add s80, s[30:31], s27 glc
    s_add_u32 s75, s75, 1
    s_waitcnt lgkmcnt(0)
    s_cmp_ge_u32 s80, 8
    s_cbranch_scc1 L_pdone_73
    s_cmp_lt_u32 s75, 200000
    s_cbranch_scc1 L_poll_72
L_pdone_73:
L_g2_71:
    s_add_u32 s77, s18, s89
    s_add_u32 s76, s18, s88
    buffer_load_dwordx4 v[128:131], v30, s[40:43], s76 offen offset:0 sc1
    buffer_load_dwordx4 v[136:139], v30, s[40:43], s77 offen offset:0 sc1
    buffer_load_dwordx4 v[132:135], v30, s[40:43], s76 offen offset:256 sc1
    buffer_load_dwordx4 v[140:143], v30, s[40:43], s77 offen offset:256 sc1
    s_waitcnt vmcnt(12)
    v_mfma_f32_16x16x32_bf16 v[32:35], v[176:179], v[144:147], v[32:35]
    v_mfma_f32_16x16x32_bf16 v[36:39], v[180:183], v[144:147], v[36:39]
    v_mfma_f32_16x16x32_bf16 v[48:51], v[176:179], v[152:155], v[48:51]
    v_mfma_f32_16x16x32_bf16 v[52:55], v[180:183], v[152:155], v[52:55]
    v_mfma_f32_16x16x32_bf16 v[64:67], v[184:187], v[144:147], v[64:67]
    v_mfma_f32_16x16x32_bf16 v[68:71], v[188:191], v[144:147], v[68:71]
    v_mfma_f32_16x16x32_bf16 v[80:83], v[184:187], v[152:155], v[80:83]
    v_mfma_f32_16x16x32_bf16 v[84:87], v[188:191], v[152:155], v[84:87]
    v_mfma_f32_16x16x32_bf16 v[40:43], v[176:179], v[148:151], v[40:43]
    v_mfma_f32_16x16x32_bf16 v[44:47], v[180:183], v[148:151], v[44:47]
    v_mfma_f32_16x16x32_bf16 v[56:59], v[176:179], v[156:159], v[56:59]
    v_mfma_f32_16x16x32_bf16 v[60:63], v[180:183], v[156:159], v[60:63]
    v_mfma_f32_16x16x32_bf16 v[72:75], v[184:187], v[148:151], v[72:75]
    v_mfma_f32_16x16x32_bf16 v[76:79], v[188:191], v[148:151], v[76:79]
    v_mfma_f32_16x16x32_bf16 v[88:91], v[184:187], v[156:159], v[88:91]
    v_mfma_f32_16x16x32_bf16 v[92:95], v[188:191], v[156:159], v[92:95]
    ds_read_b64_tr_b16 v[176:177], v28 offset:49152
    ds_read_b64_tr_b16 v[178:179], v28 offset:50176
    ds_read_b64_tr_b16 v[184:185], v29 offset:49152
    ds_read_b64_tr_b16 v[186:187], v29 offset:50176
    ds_read_b64_tr_b16 v[180:181], v28 offset:49184
    ds_read_b64_tr_b16 v[182:183], v28 offset:50208
    ds_read_b64_tr_b16 v[188:189], v29 offset:49184
    ds_read_b64_tr_b16 v[190:191], v29 offset:50208
    s_add_u32 s77, s19, s89
    s_add_u32 s76, s19, s88
    buffer_load_dwordx4 v[144:147], v30, s[40:43], s76 offen offset:0 sc1
    buffer_load_dwordx4 v[152:155], v30, s[40:43], s77 offen offset:0 sc1
    buffer_load_dwordx4 v[148:151], v30, s[40:43], s76 offen offset:256 sc1
    buffer_load_dwordx4 v[156:159], v30, s[40:43], s77 offen offset:256 sc1
    s_waitcnt vmcnt(12)
    v_mfma_f32_16x16x32_bf16 v[32:35], v[192:195], v[96:99], v[32:35]
    v_mfma_f32_16x16x32_bf16 v[36:39], v[196:199], v[96:99], v[36:39]
    v_mfma_f32_16x16x32_bf16 v[48:51], v[192:195], v[104:107], v[48:51]
    v_mfma_f32_16x16x32_bf16 v[52:55], v[196:199], v[104:107], v[52:55]
    v_mfma_f32_16x16x32_bf16 v[64:67], v[200:203], v[96:99], v[64:67]
    v_mfma_f32_16x16x32_bf16 v[68:71], v[204:207], v[96:99], v[68:71]
    v_mfma_f32_16x16x32_bf16 v[80:83], v[200:203], v[104:107], v[80:83]
    v_mfma_f32_16x16x32_bf16 v[84:87], v[204:207], v[104:107], v[84:87]
    v_mfma_f32_16x16x32_bf16 v[40:43], v[192:195], v[100:103], v[40:43]
    v_mfma_f32_16x16x32_bf16 v[44:47], v[196:199], v[100:103], v[44:47]
    v_mfma_f32_16x16x32_bf16 v[56:59], v[192:195], v[108:111], v[56:59]
    v_mfma_f32_16x16x32_bf16 v[60:63], v[196:199], v[108:111], v[60:63]
    v_mfma_f32_16x16x32_bf16 v[72:75], v[200:203], v[100:103], v[72:75]
    v_mfma_f32_16x16x32_bf16 v[76:79], v[204:207], v[100:103], v[76:79]
    v_mfma_f32_16x16x32_bf16 v[88:91], v[200:203], v[108:111], v[88:91]
    v_mfma_f32_16x16x32_bf16 v[92:95], v[204:207], v[108:111], v[92:95]
    s_add_u32 s77, s20, s89
    s_add_u32 s76, s20, s88
    buffer_load_dwordx4 v[96:99], v30, s[40:43], s76 offen offset:0 sc1
    buffer_load_dwordx4 v[104:107], v30, s[40:43], s77 offen offset:0 sc1
    buffer_load_dwordx4 v[100:103], v30, s[40:43], s76 offen offset:256 sc1
    buffer_load_dwordx4 v[108:111], v30, s[40:43], s77 offen offset:256 sc1
    s_waitcnt vmcnt(12)
    v_mfma_f32_16x16x32_bf16 v[32:35], v[208:211], v[112:115], v[32:35]
    v_mfma_f32_16x16x32_bf16 v[36:39], v[212:215], v[112:115], v[36:39]
    v_mfma_f32_16x16x32_bf16 v[48:51], v[208:211], v[120:123], v[48:51]
    v_mfma_f32_16x16x32_bf16 v[52:55], v[212:215], v[120:123], v[52:55]
    v_mfma_f32_16x16x32_bf16 v[64:67], v[216:219], v[112:115], v[64:67]
    v_mfma_f32_16x16x32_bf16 v[68:71], v[220:223], v[112:115], v[68:71]
    v_mfma_f32_16x16x32_bf16 v[80:83], v[216:219], v[120:123], v[80:83]
    v_mfma_f32_16x16x32_bf16 v[84:87], v[220:223], v[120:123], v[84:87]
    v_mfma_f32_16x16x32_bf16 v[40:43], v[208:211], v[116:119], v[40:43]
    v_mfma_f32_16x16x32_bf16 v[44:47], v[212:215], v[116:119], v[44:47]
    v_mfma_f32_16x16x32_bf16 v[56:59], v[208:211], v[124:127], v[56:59]
    v_mfma_f32_16x16x32_bf16 v[60:63], v[212:215], v[124:127], v[60:63]
    v_mfma_f32_16x16x32_bf16 v[72:75], v[216:219], v[116:119], v[72:75]
    v_mfma_f32_16x16x32_bf16 v[76:79], v[220:223], v[116:119], v[76:79]
    v_mfma_f32_16x16x32_bf16 v[88:91], v[216:219], v[124:127], v[88:91]
    v_mfma_f32_16x16x32_bf16 v[92:95], v[220:223], v[124:127], v[92:95]
    s_add_u32 s77, s21, s89
    s_add_u32 s76, s21, s88
    buffer_load_dwordx4 v[112:115], v30, s[40:43], s76 offen offset:0 sc1
    buffer_load_dwordx4 v[120:123], v30, s[40:43], s77 offen offset:0 sc1
    buffer_load_dwordx4 v[116:119], v30, s[40:43], s76 offen offset:256 sc1
    buffer_load_dwordx4 v[124:127], v30, s[40:43], s77 offen offset:256 sc1
    s_waitcnt vmcnt(12) lgkmcnt(15)
    v_mfma_f32_16x16x32_bf16 v[32:35], v[224:227], v[128:131], v[32:35]
    v_mfma_f32_16x16x32_bf16 v[36:39], v[228:231], v[128:131], v[36:39]
    v_mfma_f32_16x16x32_bf16 v[48:51], v[224:227], v[136:139], v[48:51]
    v_mfma_f32_16x16x32_bf16 v[52:55], v[228:231], v[136:139], v[52:55]
    v_mfma_f32_16x16x32_bf16 v[64:67], v[232:235], v[128:131], v[64:67]
    v_mfma_f32_16x16x32_bf16 v[68:71], v[236:239], v[128:131], v[68:71]
    v_mfma_f32_16x16x32_bf16 v[80:83], v[232:235], v[136:139], v[80:83]
    v_mfma_f32_16x16x32_bf16 v[84:87], v[236:239], v[136:139], v[84:87]
    v_mfma_f32_16x16x32_bf16 v[40:43], v[224:227], v[132:135], v[40:43]
    v_mfma_f32_16x16x32_bf16 v[44:47], v[228:231], v[132:135], v[44:47]
    v_mfma_f32_16x16x32_bf16 v[56:59], v[224:227], v[140:143], v[56:59]
    v_mfma_f32_16x16x32_bf16 v[60:63], v[228:231], v[140:143], v[60:63]
    v_mfma_f32_16x16x32_bf16 v[72:75], v[232:235], v[132:135], v[72:75]
    v_mfma_f32_16x16x32_bf16 v[76:79], v[236:239], v[132:135], v[76:79]
    v_mfma_f32_16x16x32_bf16 v[88:91], v[232:235], v[140:143], v[88:91]
    v_mfma_f32_16x16x32_bf16 v[92:95], v[236:239], v[140:143], v[92:95]
    s_waitcnt vmcnt(8)
    v_mfma_f32_16x16x32_bf16 v[32:35], v[240:243], v[144:147], v[32:35]
    v_mfma_f32_16x16x32_bf16 v[36:39], v[244:247], v[144:147], v[36:39]
    v_mfma_f32_16x16x32_bf16 v[48:51], v[240:243], v[152:155], v[48:51]
    v_mfma_f32_16x16x32_bf16 v[52:55], v[244:247], v[152:155], v[52:55]
    v_mfma_f32_16x16x32_bf16 v[64:67], v[248:251], v[144:147], v[64:67]
    v_mfma_f32_16x16x32_bf16 v[68:71], v[252:255], v[144:147], v[68:71]
    v_mfma_f32_16x16x32_bf16 v[80:83], v[248:251], v[152:155], v[80:83]
    v_mfma_f32_16x16x32_bf16 v[84:87], v[252:255], v[152:155], v[84:87]
    v_mfma_f32_16x16x32_bf16 v[40:43], v[240:243], v[148:151], v[40:43]
    v_mfma_f32_16x16x32_bf16 v[44:47], v[244:247], v[148:151], v[44:47]
    v_mfma_f32_16x16x32_bf16 v[56:59], v[240:243], v[156:159], v[56:59]
    v_mfma_f32_16x16x32_bf16 v[60:63], v[244:247], v[156:159], v[60:63]
    v_mfma_f32_16x16x32_bf16 v[72:75], v[248:251], v[148:151], v[72:75]
    v_mfma_f32_16x16x32_bf16 v[76:79], v[252:255], v[148:151], v[76:79]
    v_mfma_f32_16x16x32_bf16 v[88:91], v[248:251], v[156:159], v[88:91]
    v_mfma_f32_16x16x32_bf16 v[92:95], v[252:255], v[156:159], v[92:95]
    s_waitcnt vmcnt(0) lgkmcnt(0)
    v_mfma_f32_16x16x32_bf16 v[80:83], v[168:171], v[104:107], v[80:83]
    v_mfma_f32_16x16x32_bf16 v[84:87], v[172:175], v[104:107], v[84:87]
    v_mfma_f32_16x16x32_bf16 v[88:91], v[168:171], v[108:111], v[88:91]
    v_mfma_f32_16x16x32_bf16 v[92:95], v[172:175], v[108:111], v[92:95]
    v_mfma_f32_16x16x32_bf16 v[80:83], v[184:187], v[120:123], v[80:83]
    v_mfma_f32_16x16x32_bf16 v[84:87], v[188:191], v[120:123], v[84:87]
    v_mfma_f32_16x16x32_bf16 v[88:91], v[184:187], v[124:127], v[88:91]
    v_mfma_f32_16x16x32_bf16 v[92:95], v[188:191], v[124:127], v[92:95]
    v_mfma_f32_16x16x32_bf16 v[64:67], v[168:171], v[96:99], v[64:67]
    v_mfma_f32_16x16x32_bf16 v[68:71], v[172:175], v[96:99], v[68:71]
    v_mfma_f32_16x16x32_bf16 v[72:75], v[168:171], v[100:103], v[72:75]
    v_mfma_f32_16x16x32_bf16 v[76:79], v[172:175], v[100:103], v[76:79]
    v_mfma_f32_16x16x32_bf16 v[64:67], v[184:187], v[112:115], v[64:67]
    v_mfma_f32_16x16x32_bf16 v[68:71], v[188:191], v[112:115], v[68:71]
    ds_write_b128 v16, v[80:83] offset:32768
    ds_write_b128 v16, v[84:87] offset:33792
    v_mfma_f32_16x16x32_bf16 v[72:75], v[184:187], v[116:119], v[72:75]
    v_mfma_f32_16x16x32_bf16 v[76:79], v[188:191], v[116:119], v[76:79]
    ds_write_b128 v16, v[88:91] offset:34816
    ds_write_b128 v16, v[92:95] offset:35840
    v_mfma_f32_16x16x32_bf16 v[48:51], v[160:163], v[104:107], v[48:51]
    v_mfma_f32_16x16x32_bf16 v[52:55], v[164:167], v[104:107], v[52:55]
    v_mfma_f32_16x16x32_bf16 v[56:59], v[160:163], v[108:111], v[56:59]
    v_mfma_f32_16x16x32_bf16 v[60:63], v[164:167], v[108:111], v[60:63]
    v_mfma_f32_16x16x32_bf16 v[48:51], v[176:179], v[120:123], v[48:51]
    v_mfma_f32_16x16x32_bf16 v[52:55], v[180:183], v[120:123], v[52:55]
    ds_write_b128 v16, v[64:67] offset:16384
    ds_write_b128 v16, v[68:71] offset:17408
    v_mfma_f32_16x16x32_bf16 v[56:59], v[176:179], v[124:127], v[56:59]
    v_mfma_f32_16x16x32_bf16 v[60:63], v[180:183], v[124:127], v[60:63]
    ds_write_b128 v16, v[72:75] offset:18432
    ds_write_b128 v16, v[76:79] offset:19456
    v_mfma_f32_16x16x32_bf16 v[32:35], v[160:163], v[96:99], v[32:35]
    v_mfma_f32_16x16x32_bf16 v[36:39], v[164:167], v[96:99], v[36:39]
    v_mfma_f32_16x16x32_bf16 v[40:43], v[160:163], v[100:103], v[40:43]
    v_mfma_f32_16x16x32_bf16 v[44:47], v[164:167], v[100:103], v[44:47]
    v_mfma_f32_16x16x32_bf16 v[32:35], v[176:179], v[112:115], v[32:35]
    v_mfma_f32_16x16x32_bf16 v[36:39], v[180:183], v[112:115], v[36:39]
    ds_write_b128 v16, v[48:51] offset:0
    ds_write_b128 v16, v[52:55] offset:1024
    v_mfma_f32_16x16x32_bf16 v[40:43], v[176:179], v[116:119], v[40:43]
    v_mfma_f32_16x16x32_bf16 v[44:47], v[180:183], v[116:119], v[44:47]
    ds_write_b128 v16, v[56:59] offset:2048
    ds_write_b128 v16, v[60:63] offset:3072
    s_waitcnt lgkmcnt(0)
    s_barrier
    ds_read_b128 v[96:99], v17 offset:0
    ds_read_b128 v[100:103], v17 offset:1024
    ds_read_b128 v[104:107], v17 offset:2048
    ds_read_b128 v[108:111], v17 offset:3072
    ds_read_b128 v[112:115], v22 offset:0
    ds_read_b128 v[116:119], v22 offset:1024
    ds_read_b128 v[120:123], v22 offset:2048
    ds_read_b128 v[124:127], v22 offset:3072
    ds_read_b128 v[128:131], v23 offset:0
    ds_read_b128 v[132:135], v23 offset:1024
    ds_read_b128 v[136:139], v23 offset:2048
    ds_read_b128 v[140:143], v23 offset:3072
    s_waitcnt lgkmcnt(8)
    v_pk_add_f32 v[32:33], v[32:33], v[96:97]
    v_pk_add_f32 v[34:35], v[34:35], v[98:99]
    v_pk_add_f32 v[36:37], v[36:37], v[100:101]
    v_pk_add_f32 v[38:39], v[38:39], v[102:103]
    v_pk_add_f32 v[40:41], v[40:41], v[104:105]
    v_pk_add_f32 v[42:43], v[42:43], v[106:107]
    v_pk_add_f32 v[44:45], v[44:45], v[108:109]
    v_pk_add_f32 v[46:47], v[46:47], v[110:111]
    s_waitcnt lgkmcnt(4)
    v_pk_add_f32 v[32:33], v[32:33], v[112:113]
    v_pk_add_f32 v[34:35], v[34:35], v[114:115]
    v_pk_add_f32 v[36:37], v[36:37], v[116:117]
    v_pk_add_f32 v[38:39], v[38:39], v[118:119]
    v_pk_add_f32 v[40:41], v[40:41], v[120:121]
    v_pk_add_f32 v[42:43], v[42:43], v[122:123]
    v_pk_add_f32 v[44:45], v[44:45], v[124:125]
    v_pk_add_f32 v[46:47], v[46:47], v[126:127]
    s_waitcnt lgkmcnt(0)
    v_pk_add_f32 v[32:33], v[32:33], v[128:129]
    v_pk_add_f32 v[34:35], v[34:35], v[130:131]
    v_pk_add_f32 v[36:37], v[36:37], v[132:133]
    v_pk_add_f32 v[38:39], v[38:39], v[134:135]
    v_pk_add_f32 v[40:41], v[40:41], v[136:137]
    v_pk_add_f32 v[42:43], v[42:43], v[138:139]
    v_pk_add_f32 v[44:45], v[44:45], v[140:141]
    v_pk_add_f32 v[46:47], v[46:47], v[142:143]
    v_cvt_pk_bf16_f32 v48, v32, v33
    v_cvt_pk_bf16_f32 v49, v34, v35
    v_cvt_pk_bf16_f32 v50, v36, v37
    v_cvt_pk_bf16_f32 v51, v38, v39
    v_cvt_pk_bf16_f32 v52, v40, v41
    v_cvt_pk_bf16_f32 v53, v42, v43
    v_cvt_pk_bf16_f32 v54, v44, v45
    v_cvt_pk_bf16_f32 v55, v46, v47
    s_add_u32 s76, s72, 14336
    v_permlane16_swap_b32 v48, v50
    v_permlane16_swap_b32 v49, v51
    v_permlane16_swap_b32 v52, v54
    v_permlane16_swap_b32 v53, v55
    buffer_store_dwordx4 v[48:51], v20, s[56:59], s72 offen sc1
    buffer_store_dwordx4 v[52:55], v20, s[56:59], s76 offen sc1
L_finH:
    s_endpgm
L_idle:
    s_cmp_ge_u32 s87, 4
    s_cbranch_scc1 L_finH
    s_branch L_finM
L_end:
    s_endpgm
L_code_end:
.section .rodata,"a"
.p2align 6
.amdhsa_kernel sequential_preLN__linear_kernel_hedgehog__mixer_channel_mlp__prompt_kernel
  .amdhsa_next_free_vgpr 256
  .amdhsa_next_free_sgpr 100
  .amdhsa_accum_offset 256
  .amdhsa_group_segment_fixed_size 0
  .amdhsa_kernarg_size 96
  .amdhsa_user_sgpr_count 2
  .amdhsa_user_sgpr_kernarg_segment_ptr 1
  .amdhsa_system_sgpr_workgroup_id_x 1
.end_amdhsa_kernel
```
